```python
import torch

def _softmax(x, axis=-1):
    return torch.softmax(x, dim=axis)
def _gelu(x):
    return torch.nn.functional.gelu(x, approximate="tanh")
def _silu(x):
    return torch.nn.functional.silu(x)
def _sigmoid(x):
    return torch.sigmoid(x)
def _layernorm(x, axis=-1, eps=1e-5):
    m = x.mean(dim=axis, keepdim=True)
    v = x.var(dim=axis, keepdim=True, unbiased=False)
    return (x - m) / torch.sqrt(v + eps)
def _scatter_add(tgt, idx, src, axis=0):
    return tgt.clone().index_add_(axis, idx, src)
def _segment_sum(src, seg, n):
    out = torch.zeros((n,) + src.shape[1:], dtype=src.dtype)
    return out.index_add_(0, seg, src)
def _pad(x, pw):
    flat = tuple(v for pair in reversed(pw) for v in pair)
    return torch.nn.functional.pad(x, flat)

kernel_name = 'recurrent_scan__sliding_local_dilated__swiglu_ffn__prompt'

def setup_inputs():

    _w = (lambda a: (lambda t: t.to(torch.bfloat16) if t.is_floating_point() else t)(torch.as_tensor(a)))
    def _A_setup():
        B, S, D = 1, 2048, 512
        return {
            "x": _w((lambda *s: torch.randn(*s, dtype=torch.bfloat16) * 0.05)(B, S, D)),
            "wqkv": _w((lambda *s: torch.randn(*s, dtype=torch.bfloat16) * 0.05)(D, 3 * D)),
            "wo": _w((lambda *s: torch.randn(*s, dtype=torch.bfloat16) * 0.05)(D, D)),
        }
    _A_in = _A_setup()

    def _B_setup():
        B, S, D, F = 1, 2048, 512, 1376
        return {
            "x": _w((lambda *s: torch.randn(*s, dtype=torch.bfloat16) * 0.05)(B, S, D)),
            "w_gate": _w((lambda *s: torch.randn(*s, dtype=torch.bfloat16) * 0.05)(D, F)),
            "w_up": _w((lambda *s: torch.randn(*s, dtype=torch.bfloat16) * 0.05)(D, F)),
            "w_down": _w((lambda *s: torch.randn(*s, dtype=torch.bfloat16) * 0.05)(F, D)),
        }
    _B_in = _B_setup()

    return {
        "A_x": _A_in["x"],
        "A_wqkv": _A_in["wqkv"],
        "A_wo": _A_in["wo"],
        "B_x": _B_in["x"],
        "B_w_gate": _B_in["w_gate"],
        "B_w_up": _B_in["w_up"],
        "B_w_down": _B_in["w_down"],
    }

def reference(A_x, A_wqkv, A_wo, B_x, B_w_gate, B_w_up, B_w_down):
    def _A_ref(x, wqkv, wo):
        B, S, D = x.shape
        H = 32; Dh = D // H
        W, dil = 8, 2
        qkv = (lambda x, *d: x.permute(*d))((x @ wqkv).reshape(B, S, 3, H, Dh), 2, 0, 3, 1, 4)
        q, k, v = qkv[0], qkv[1], qkv[2]
        scale = Dh ** -0.5
        pos = torch.arange(S)
        off = torch.arange(W) * dil
        idx = pos[:, None] - off[None, :]
        mask = idx >= 0
        idx_c = torch.where(mask, idx, 0).reshape(-1)
        kg = k[:, :, idx_c, :].reshape(B, H, S, W, Dh)
        vg = v[:, :, idx_c, :].reshape(B, H, S, W, Dh)
        logits = torch.einsum("bhsd,bhswd->bhsw", q, kg) * scale
        logits = torch.where(mask[None, None, :, :], logits, -1e9)
        attn = _softmax(logits, axis=-1)
        o = torch.einsum("bhsw,bhswd->bhsd", attn, vg)
        return (lambda x, *d: x.permute(*d))(o, 0, 2, 1, 3).reshape(B, S, D) @ wo

    def _B_ref(x, w_gate, w_up, w_down):
        g = _silu(x @ w_gate)
        u = x @ w_up
        return (g * u) @ w_down

    x = A_x
    xn = _layernorm(x, axis=-1)
    s = _A_ref(xn, A_wqkv, A_wo)
    g = _silu(_B_ref(xn, B_w_gate, B_w_up, B_w_down))
    return x + s * g
```

```asm
; @launch grid=(256,1,1) block=(512,1,1) lds=163840
.amdgcn_target "amdgcn-amd-amdhsa--gfx950"
.text
.globl recurrent_scan__sliding_local_dilated__swiglu_ffn__prompt_kernel
.p2align 8
.type recurrent_scan__sliding_local_dilated__swiglu_ffn__prompt_kernel,@function
recurrent_scan__sliding_local_dilated__swiglu_ffn__prompt_kernel:
KSTART:
  s_cmp_ge_u32 s2, 256
  s_cbranch_scc1 L_END
  s_load_dwordx16 s[4:19], s[0:1], 0
  s_load_dwordx4 s[20:23], s[0:1], 64
  s_memrealtime s[44:45]
  s_getpc_b64 s[68:69]
L_PC:
  s_and_b32 s70, s2, 0xf8
  v_lshrrev_b32 v1, 6, v0
  v_and_b32 v254, 63, v0
  v_add_u32 v2, s70, v1
  v_lshlrev_b32 v2, 7, v2
  v_min_u32 v2, L_CODE_END-L_PC-4, v2
  global_load_dword v253, v2, s[68:69]
  v_readfirstlane_b32 s56, v1
  v_xor_b32 v1, 4, v1
  v_lshlrev_b32 v1, 2, v1
  v_add_u32 v1, 159696, v1
  v_mov_b32 v2, 0
  ds_write_b32 v1, v2
  s_and_b32 s66, s2, 7
  s_lshr_b32 s63, s2, 3
  s_lshl_b32 s61, s66, 2
  s_lshr_b32 s68, 0x76543210, s61
  s_and_b32 s67, s68, 1
  s_bfe_u32 s68, s68, 0x20001
  s_lshr_b32 s61, 0x37261504, s61
  s_and_b32 s61, s61, 7
  s_lshl_b32 s61, s61, 2
  s_lshr_b32 s69, s63, 3
  s_add_u32 s61, s61, s69
  s_add_u32 s62, s63, 0
  s_and_b32 s62, s62, 7
  s_mul_i32 s69, s63, 52
  s_lshr_b32 s69, s69, 8
  s_mul_i32 s70, s69, 5
  s_sub_u32 s70, s63, s70
  s_mul_i32 s71, s67, 6
  s_add_u32 s57, s70, s71
  s_mul_i32 s71, s68, 6
  s_add_u32 s58, s71, s69
  s_lshl_b32 s72, s67, 1
  s_add_u32 s71, s71, s72
  s_add_u32 s71, s71, s63
  s_sub_u32 s71, s71, 30
  s_cmp_eq_u32 s67, 0
  s_mov_b32 s72, 0x100b1615
  s_mov_b32 s73, 0x001f1f11
  s_cmov_b32 s72, 0x04141312
  s_cmov_b32 s73, 0x001f0a05
  s_sub_u32 s74, s63, 25
  s_lshl_b32 s74, s74, 3
  s_lshr_b64 s[72:73], s[72:73], s74
  s_and_b32 s72, s72, 0xff
  s_cmp_eq_u32 s68, 3
  s_cselect_b32 s71, s72, s71
  s_cselect_b32 s73, 25, 30
  s_cmp_ge_u32 s63, s73
  s_cselect_b32 s58, s71, s58
  s_cselect_b32 s57, 5, s57
  s_cmp_eq_u32 s58, 31
  s_cselect_b32 s58, 0, s58
  s_cselect_b32 s57, 11, s57
  s_mul_i32 s71, s58, 43
  s_lshr_b32 s71, s71, 8
  s_mul_i32 s72, s71, 6
  s_sub_u32 s72, s58, s72
  s_cmp_eq_u32 s71, 3
  s_cselect_b32 s73, 3, 4
  s_lshl_b32 s74, s71, 1
  s_add_u32 s58, s74, s72
  s_add_u32 s74, s74, s58
  s_add_u32 s58, s58, 15
  s_sub_u32 s58, s58, s73
  s_cmp_lt_u32 s72, s73
  s_cselect_b32 s58, s74, s58
  s_cmp_ge_u32 s58, 15
  s_cselect_b32 s59, 1, 0
  s_and_b32 s60, s56, 3
  s_cmp_eq_u32 s57, 5
  s_cselect_b32 s70, 5, s70
  s_lshr_b32 s71, s70, 1
  s_lshr_b32 s73, s72, 1
  s_add_u32 s71, s71, s73
  s_add_u32 s71, s71, s67
  s_cmp_ge_u32 s71, 3
  s_cselect_b32 s73, 3, 0
  s_sub_u32 s71, s71, s73
  s_mul_i32 s3, s71, 3
  s_add_u32 s3, s3, 0
  s_and_b32 s3, s3, 7
  s_cmp_eq_u32 s67, 0
  s_movk_i32 s73, 658
  s_cmov_b32 s73, 68
  s_lshl_b32 s71, s70, 1
  s_lshr_b32 s73, s73, s71
  s_and_b32 s73, s73, 3
  s_lshl_b32 s73, s73, 2
  s_and_b32 s71, s71, 2
  s_or_b32 s73, s73, s71
  s_and_b32 s72, s72, 1
  s_or_b32 s46, s73, s72
  s_cmp_lt_u32 s56, 4
  s_cbranch_scc0 L_H
  s_or_b32 s66, s2, s56
  s_cmp_lg_u32 s66, 0
  s_waitcnt lgkmcnt(0)
  s_cbranch_scc1 L_NW
  v_mov_b32 v2, s44
  v_mov_b32 v3, s45
  v_mov_b32 v4, 0
  global_store_dwordx2 v4, v[2:3], s[20:21] sc1
L_NW:
  s_mov_b32 s24, s4
  s_mov_b32 s25, s5
  s_mov_b32 s26, 2097152
  s_mov_b32 s27, 0x20000
  s_mul_i32 s66, s57, 192
  s_mul_i32 s67, s58, 12
  s_add_u32 s66, s66, s67
  s_mul_i32 s67, s60, 3
  s_add_u32 s66, s66, s67
  s_cmp_lt_u32 s58, 16
  s_cselect_b32 s75, s66, 0x100000
  s_lshl_b32 s66, s75, 10
  v_lshlrev_b32 v7, 4, v254
  buffer_load_dwordx4 v[200:203], v7, s[24:27], s66 offen offset:0
  buffer_load_dwordx4 v[204:207], v7, s[24:27], s66 offen offset:1024
  buffer_load_dwordx4 v[208:211], v7, s[24:27], s66 offen offset:2048
  s_barrier
  s_branch L_C
L_H:
  v_lshrrev_b32 v8, 3, v254
  v_and_b32 v9, 7, v254
  v_lshrrev_b32 v10, 1, v8
  s_and_b32 s66, s60, 1
  s_lshl_b32 s67, s66, 2
  v_or_b32 v11, s67, v10
  v_xor_b32 v11, v11, v9
  v_lshlrev_b32 v11, 4, v11
  s_mul_i32 s68, s57, 192
  s_lshl_b32 s69, s59, 4
  s_sub_i32 s68, s68, s69
  s_lshl_b32 s69, s60, 3
  s_add_i32 s68, s68, s69
  s_add_i32 s70, s68, 32
  v_add_u32 v3, s70, v8
  v_lshlrev_b32 v3, 10, v3
  v_add_u32 v3, v3, v11
  s_cmp_lt_i32 s68, 0
  s_mov_b32 s70, -32768
  s_cmov_b32 s70, 0x40000000
  v_add_u32 v2, s70, v3
  v_lshlrev_b32 v7, 4, v254
  s_cmp_eq_u32 s59, 1
  s_cbranch_scc1 L_HQ
  s_mul_i32 s68, s60, 44032
  s_mul_i32 s69, s58, 192
  s_add_u32 s68, s68, s69
  s_movk_i32 s70, 171
  s_movk_i32 s71, 2752
  s_sub_u32 s72, 2752, s69
  v_add_u32 v12, 0, v254
  v_mul_u32_u24 v13, s70, v12
  v_lshrrev_b32 v13, 11, v13
  v_mul_u32_u24 v14, 12, v13
  v_sub_u32 v14, v12, v14
  v_bfe_u32 v15, v13, 3, 1
  v_lshlrev_b32 v15, 1, v15
  v_xor_b32 v14, v14, v15
  v_lshlrev_b32 v14, 4, v14
  v_mad_u32_u24 v4, v13, s71, v14
  v_add_u32 v4, s68, v4
  v_cmp_gt_u32 vcc, s72, v14
  v_mov_b32 v15, 2130706432
  s_nop 0
  v_cndmask_b32 v4, v15, v4, vcc
  v_add_u32 v12, 64, v254
  v_mul_u32_u24 v13, s70, v12
  v_lshrrev_b32 v13, 11, v13
  v_mul_u32_u24 v14, 12, v13
  v_sub_u32 v14, v12, v14
  v_bfe_u32 v15, v13, 3, 1
  v_lshlrev_b32 v15, 1, v15
  v_xor_b32 v14, v14, v15
  v_lshlrev_b32 v14, 4, v14
  v_mad_u32_u24 v5, v13, s71, v14
  v_add_u32 v5, s68, v5
  v_cmp_gt_u32 vcc, s72, v14
  v_mov_b32 v15, 2130706432
  s_nop 0
  v_cndmask_b32 v5, v15, v5, vcc
  v_add_u32 v12, 128, v254
  v_mul_u32_u24 v13, s70, v12
  v_lshrrev_b32 v13, 11, v13
  v_mul_u32_u24 v14, 12, v13
  v_sub_u32 v14, v12, v14
  v_bfe_u32 v15, v13, 3, 1
  v_lshlrev_b32 v15, 1, v15
  v_xor_b32 v14, v14, v15
  v_lshlrev_b32 v14, 4, v14
  v_mad_u32_u24 v6, v13, s71, v14
  v_add_u32 v6, s68, v6
  v_cmp_gt_u32 vcc, s72, v14
  v_mov_b32 v15, 2130706432
  s_nop 0
  v_cndmask_b32 v6, v15, v6, vcc
  s_mul_i32 s80, s60, 3072
  s_add_u32 s80, s80, 24576
  s_add_u32 s81, s80, 1024
  s_add_u32 s82, s80, 2048
  s_add_u32 s83, s80, 12288
  s_add_u32 s84, s80, 13312
  s_add_u32 s85, s80, 14336
  s_mov_b32 s86, 176128
  s_mov_b32 s87, 0
  s_mov_b32 s77, 0
  s_waitcnt lgkmcnt(0)
  s_mov_b32 s28, s12
  s_mov_b32 s29, s13
  s_mov_b32 s30, 1409024
  s_mov_b32 s31, 0x20000
  s_mov_b32 s32, s14
  s_mov_b32 s33, s15
  s_mov_b32 s34, 1409024
  s_mov_b32 s35, 0x20000
  s_branch L_HJ
L_HQ:
  v_and_b32 v12, 1, v10
  s_lshl_b32 s67, s66, 1
  v_or_b32 v12, s67, v12
  v_lshlrev_b32 v12, 1, v12
  v_xor_b32 v12, v12, v9
  v_lshlrev_b32 v12, 4, v12
  s_movk_i32 s71, 3072
  v_mad_u32_u24 v4, v8, s71, v12
  s_mul_i32 s68, s60, 24576
  s_sub_u32 s69, s58, 15
  s_lshl_b32 s69, s69, 7
  s_add_u32 s68, s68, s69
  v_add_u32 v4, s68, v4
  v_add_u32 v5, 1024, v4
  v_add_u32 v6, 2048, v4
  s_lshl_b32 s80, s60, 10
  s_add_u32 s80, s80, 26624
  s_add_u32 s81, s80, 8192
  s_add_u32 s82, s80, 16384
  s_add_u32 s83, s80, 4096
  s_add_u32 s84, s80, 12288
  s_add_u32 s85, s80, 20480
  s_mov_b32 s86, 196608
  s_mov_b32 s87, 98304
  s_cmp_lt_u32 s60, 2
  s_cselect_b32 s77, 1, 0
  s_waitcnt lgkmcnt(0)
  s_mov_b32 s28, s6
  s_mov_b32 s29, s7
  s_mov_b32 s30, 1572864
  s_mov_b32 s31, 0x20000
  s_mov_b32 s32, s6
  s_mov_b32 s33, s7
  s_mov_b32 s34, 1572864
  s_mov_b32 s35, 0x20000
L_HJ:
  s_mov_b32 s24, s4
  s_mov_b32 s25, s5
  s_mov_b32 s26, 2097152
  s_mov_b32 s27, 0x20000
  s_lshl_b32 s76, s60, 10
  s_add_u32 s68, s3, 0
  s_and_b32 s68, s68, 7
  s_lshl_b32 s79, s68, 7
  s_mul_i32 s88, s68, s86
  s_add_u32 s67, s88, s87
  s_bitcmp1_b32 s46, 1
  s_cbranch_scc1 L_ha_1
  s_add_u32 m0, s80, 0
  s_nop 0
  buffer_load_dwordx4 v4, s[28:31], s88 offen lds
  s_add_u32 m0, s81, 0
  s_nop 0
  buffer_load_dwordx4 v5, s[28:31], s88 offen lds
  s_add_u32 m0, s82, 0
  s_nop 0
  buffer_load_dwordx4 v6, s[28:31], s88 offen lds
  s_branch L_hb_2
L_ha_1:
  s_add_u32 m0, s83, 0
  s_nop 0
  buffer_load_dwordx4 v4, s[32:35], s67 offen lds
  s_add_u32 m0, s84, 0
  s_nop 0
  buffer_load_dwordx4 v5, s[32:35], s67 offen lds
  s_add_u32 m0, s85, 0
  s_nop 0
  buffer_load_dwordx4 v6, s[32:35], s67 offen lds
L_hb_2:
  s_bitcmp1_b32 s46, 0
  s_cbranch_scc1 L_ha_3
  s_add_u32 m0, s76, 0
  s_nop 0
  buffer_load_dwordx4 v2, s[24:27], s79 offen lds
  s_add_u32 m0, s76, 4096
  s_nop 0
  buffer_load_dwordx4 v3, s[24:27], s79 offen lds
  s_add_u32 m0, s76, 8192
  s_add_u32 s66, s79, 32768
  buffer_load_dwordx4 v3, s[24:27], s66 offen lds
  s_branch L_hb_4
L_ha_3:
  s_add_u32 m0, s76, 12288
  s_add_u32 s66, s79, 65536
  buffer_load_dwordx4 v3, s[24:27], s66 offen lds
  s_add_u32 m0, s76, 16384
  s_add_u32 s66, s79, 98304
  buffer_load_dwordx4 v3, s[24:27], s66 offen lds
  s_add_u32 m0, s76, 20480
  s_add_u32 s66, s79, 131072
  buffer_load_dwordx4 v3, s[24:27], s66 offen lds
L_hb_4:
  s_setprio 0
  s_barrier
  s_bitcmp0_b32 s46, 1
  s_cbranch_scc1 L_ha_5
  s_add_u32 m0, s80, 0
  s_nop 0
  buffer_load_dwordx4 v4, s[28:31], s88 offen lds
  s_add_u32 m0, s81, 0
  s_nop 0
  buffer_load_dwordx4 v5, s[28:31], s88 offen lds
  s_add_u32 m0, s82, 0
  s_nop 0
  buffer_load_dwordx4 v6, s[28:31], s88 offen lds
  s_branch L_hb_6
L_ha_5:
  s_add_u32 m0, s83, 0
  s_nop 0
  buffer_load_dwordx4 v4, s[32:35], s67 offen lds
  s_add_u32 m0, s84, 0
  s_nop 0
  buffer_load_dwordx4 v5, s[32:35], s67 offen lds
  s_add_u32 m0, s85, 0
  s_nop 0
  buffer_load_dwordx4 v6, s[32:35], s67 offen lds
L_hb_6:
  s_bitcmp0_b32 s46, 0
  s_cbranch_scc1 L_ha_7
  s_add_u32 m0, s76, 0
  s_nop 0
  buffer_load_dwordx4 v2, s[24:27], s79 offen lds
  s_add_u32 m0, s76, 4096
  s_nop 0
  buffer_load_dwordx4 v3, s[24:27], s79 offen lds
  s_add_u32 m0, s76, 8192
  s_add_u32 s66, s79, 32768
  buffer_load_dwordx4 v3, s[24:27], s66 offen lds
  s_branch L_hb_8
L_ha_7:
  s_add_u32 m0, s76, 12288
  s_add_u32 s66, s79, 65536
  buffer_load_dwordx4 v3, s[24:27], s66 offen lds
  s_add_u32 m0, s76, 16384
  s_add_u32 s66, s79, 98304
  buffer_load_dwordx4 v3, s[24:27], s66 offen lds
  s_add_u32 m0, s76, 20480
  s_add_u32 s66, s79, 131072
  buffer_load_dwordx4 v3, s[24:27], s66 offen lds
L_hb_8:
  s_cmp_eq_u32 s77, 0
  s_cbranch_scc1 L_x7_9
  s_add_u32 m0, s76, 24576
  s_add_u32 s66, s79, 163840
  buffer_load_dwordx4 v3, s[24:27], s66 offen lds
L_x7_9:
  v_mov_b32 v236, 159696
  s_lshl_b32 s66, s60, 2
  v_add_u32 v238, s66, v236
  s_lshr_b32 s66, s60, 1
  s_mul_i32 s66, s66, 12288
  s_and_b32 s67, s60, 1
  s_lshl_b32 s67, s67, 7
  s_add_u32 s66, s66, s67
  s_add_u32 s66, s66, 24576
  s_lshl_b32 s67, s60, 13
  s_add_u32 s67, s67, 26624
  s_cmp_eq_u32 s59, 1
  s_cselect_b32 s66, s67, s66
  s_movk_i32 s67, 192
  s_cmov_b32 s67, 128
  s_cselect_b32 s68, 2, 0
  s_cselect_b32 s69, 64, 32
  v_and_b32 v64, s68, v8
  v_xor_b32 v64, v64, v9
  v_lshlrev_b32 v64, 4, v64
  v_mad_u32_u24 v64, v8, s67, v64
  v_add_u32 v64, s66, v64
  v_xor_b32 v65, s69, v64
  s_lshl_b32 s67, s67, 3
  v_add_u32 v65, s67, v65
  s_lshl_b32 s71, s67, 1
  s_mov_b32 s78, s71
  s_mov_b32 s36, s22
  s_mov_b32 s37, s23
  s_mov_b32 s38, 16777216
  s_mov_b32 s39, 0x20000
  s_mov_b32 s40, s22
  s_mov_b32 s41, s23
  s_mov_b32 s42, 7733248
  s_mov_b32 s43, 0x20000
  s_lshl_b32 s68, s56, 3
  s_mov_b32 s66, 807407616
  s_mov_b32 s67, 1750748480
  s_lshr_b64 s[66:67], s[66:67], s68
  s_and_b32 s94, s66, 0xff
  s_mov_b32 s66, 269488144
  s_mov_b32 s67, 235801869
  s_lshr_b64 s[66:67], s[66:67], s68
  s_and_b32 s92, s66, 0xff
  s_lshl_b32 s69, s62, 7
  s_add_u32 s69, s69, 5120
  s_add_u32 s93, s94, s69
  s_lshl_b32 s68, s60, 3
  s_mov_b32 s66, 807407616
  s_mov_b32 s67, 1750748480
  s_lshr_b64 s[66:67], s[66:67], s68
  s_and_b32 s100, s66, 0xff
  s_mov_b32 s66, 269488144
  s_mov_b32 s67, 235801869
  s_lshr_b64 s[66:67], s[66:67], s68
  s_and_b32 s101, s66, 0xff
  s_add_u32 s100, s100, s69
  s_lshl_b32 s95, s60, 11
  s_mul_i32 s91, s62, 2
  s_mul_i32 s66, s61, 4
  s_add_u32 s91, s91, s66
  s_and_b32 s91, s91, 15
  s_cmp_ge_u32 s91, s101
  s_cselect_b32 s66, s101, 0
  s_sub_u32 s47, s91, s66
  s_cmp_ge_u32 s91, s92
  s_cselect_b32 s66, s92, 0
  s_sub_u32 s91, s91, s66
  s_mul_i32 s66, s61, 236
  s_add_u32 s94, s94, s66
  v_lshlrev_b32 v246, 4, v254
  v_add_u32 v240, s95, v246
  v_add_u32 v241, 0x10000, v240
  v_add_u32 v242, 0x20000, v240
  v_and_b32 v12, 4, v8
  v_and_b32 v13, 1, v8
  v_add_u32 v12, v12, v13
  v_bfe_u32 v13, v254, 2, 1
  v_lshl_add_u32 v12, v13, 1, v12
  v_lshlrev_b32 v12, 10, v12
  v_bfe_u32 v13, v8, 1, 1
  v_lshl_add_u32 v12, v13, 6, v12
  v_and_b32 v13, 3, v254
  v_lshl_add_u32 v247, v13, 4, v12
  s_lshl_b32 s66, s60, 9
  s_lshl_b32 s67, s58, 14
  s_add_u32 s66, s66, s67
  s_add_u32 s66, s66, 8454144
  v_and_b32 v200, 31, v254
  v_lshlrev_b32 v200, 4, v200
  v_lshrrev_b32 v201, 5, v254
  v_lshl_add_u32 v200, v201, 13, v200
  v_add_u32 v200, s66, v200
  s_lshl_b32 s66, s60, 6
  v_add_u32 v202, s66, v254
  s_mul_i32 s66, s57, 192
  s_lshl_b32 s67, s59, 4
  s_sub_i32 s66, s66, s67
  v_add_u32 v201, s66, v202
  s_add_u32 s67, s67, 192
  v_cmp_gt_u32 vcc, s67, v202
  s_nop 0
  s_mov_b64 s[68:69], vcc
  v_mov_b32 v203, 2048
  v_cmp_gt_u32 vcc, v203, v201
  s_nop 0
  s_and_b64 s[74:75], vcc, s[68:69]
  v_lshlrev_b32 v201, 4, v201
  v_add_u32 v201, 8388608, v201
  v_mov_b32 v203, 2130706432
  v_cndmask_b32 v201, v203, v201, s[74:75]
  v_lshlrev_b32 v204, 4, v202
  v_add_u32 v204, 155648, v204
  v_mov_b32 v203, 162816
  v_cndmask_b32 v204, v203, v204, s[68:69]
  v_lshlrev_b32 v205, 2, v202
  v_add_u32 v205, 159744, v205
  s_lshl_b32 s66, s60, 8
  s_add_u32 s66, s66, 161792
  v_and_b32 v203, 31, v254
  v_lshlrev_b32 v203, 3, v203
  v_add_u32 v203, s66, v203
  v_and_b32 v206, 15, v254
  v_mov_b32 v207, s93
  v_mov_b32 v208, s100
  v_mov_b32 v209, s92
  v_mov_b32 v210, s101
  v_cmp_gt_u32 vcc, 32, v254
  s_nop 1
  v_cndmask_b32 v207, v208, v207, vcc
  v_cndmask_b32 v209, v210, v209, vcc
  v_add_u32 v209, -1, v209
  v_min_u32 v206, v206, v209
  v_add_u32 v206, v206, v207
  v_subrev_u32 v206, 5120, v206
  v_lshlrev_b32 v206, 4, v206
  v_add_u32 v206, 8978432, v206
  s_add_u32 s68, s3, 1
  s_and_b32 s68, s68, 7
  s_lshl_b32 s79, s68, 7
  s_mul_i32 s88, s68, s86
  s_add_u32 s67, s88, s87
  s_bitcmp1_b32 s46, 1
  s_cbranch_scc1 L_ha_10
  s_add_u32 m0, s80, 51200
  s_nop 0
  buffer_load_dwordx4 v4, s[28:31], s88 offen lds
  s_add_u32 m0, s81, 51200
  s_nop 0
  buffer_load_dwordx4 v5, s[28:31], s88 offen lds
  s_add_u32 m0, s82, 51200
  s_nop 0
  buffer_load_dwordx4 v6, s[28:31], s88 offen lds
  s_branch L_hb_11
L_ha_10:
  s_add_u32 m0, s83, 51200
  s_nop 0
  buffer_load_dwordx4 v4, s[32:35], s67 offen lds
  s_add_u32 m0, s84, 51200
  s_nop 0
  buffer_load_dwordx4 v5, s[32:35], s67 offen lds
  s_add_u32 m0, s85, 51200
  s_nop 0
  buffer_load_dwordx4 v6, s[32:35], s67 offen lds
L_hb_11:
  s_bitcmp1_b32 s46, 0
  s_cbranch_scc1 L_ha_12
  s_add_u32 m0, s76, 51200
  s_nop 0
  buffer_load_dwordx4 v2, s[24:27], s79 offen lds
  s_add_u32 m0, s76, 55296
  s_nop 0
  buffer_load_dwordx4 v3, s[24:27], s79 offen lds
  s_add_u32 m0, s76, 59392
  s_add_u32 s66, s79, 32768
  buffer_load_dwordx4 v3, s[24:27], s66 offen lds
  s_branch L_hb_13
L_ha_12:
  s_add_u32 m0, s76, 63488
  s_add_u32 s66, s79, 65536
  buffer_load_dwordx4 v3, s[24:27], s66 offen lds
  s_add_u32 m0, s76, 67584
  s_add_u32 s66, s79, 98304
  buffer_load_dwordx4 v3, s[24:27], s66 offen lds
  s_add_u32 m0, s76, 71680
  s_add_u32 s66, s79, 131072
  buffer_load_dwordx4 v3, s[24:27], s66 offen lds
L_hb_13:
  s_waitcnt vmcnt(6)
  v_mov_b32 v237, 1
  ds_write_b32 v238, v237
  s_bitcmp0_b32 s46, 1
  s_cbranch_scc1 L_ha_14
  s_add_u32 m0, s80, 51200
  s_nop 0
  buffer_load_dwordx4 v4, s[28:31], s88 offen lds
  s_add_u32 m0, s81, 51200
  s_nop 0
  buffer_load_dwordx4 v5, s[28:31], s88 offen lds
  s_add_u32 m0, s82, 51200
  s_nop 0
  buffer_load_dwordx4 v6, s[28:31], s88 offen lds
  s_branch L_hb_15
L_ha_14:
  s_add_u32 m0, s83, 51200
  s_nop 0
  buffer_load_dwordx4 v4, s[32:35], s67 offen lds
  s_add_u32 m0, s84, 51200
  s_nop 0
  buffer_load_dwordx4 v5, s[32:35], s67 offen lds
  s_add_u32 m0, s85, 51200
  s_nop 0
  buffer_load_dwordx4 v6, s[32:35], s67 offen lds
L_hb_15:
  s_bitcmp0_b32 s46, 0
  s_cbranch_scc1 L_ha_16
  s_add_u32 m0, s76, 51200
  s_nop 0
  buffer_load_dwordx4 v2, s[24:27], s79 offen lds
  s_add_u32 m0, s76, 55296
  s_nop 0
  buffer_load_dwordx4 v3, s[24:27], s79 offen lds
  s_add_u32 m0, s76, 59392
  s_add_u32 s66, s79, 32768
  buffer_load_dwordx4 v3, s[24:27], s66 offen lds
  s_branch L_hb_17
L_ha_16:
  s_add_u32 m0, s76, 63488
  s_add_u32 s66, s79, 65536
  buffer_load_dwordx4 v3, s[24:27], s66 offen lds
  s_add_u32 m0, s76, 67584
  s_add_u32 s66, s79, 98304
  buffer_load_dwordx4 v3, s[24:27], s66 offen lds
  s_add_u32 m0, s76, 71680
  s_add_u32 s66, s79, 131072
  buffer_load_dwordx4 v3, s[24:27], s66 offen lds
L_hb_17:
  s_cmp_eq_u32 s77, 0
  s_cbranch_scc1 L_x7_18
  s_add_u32 m0, s76, 75776
  s_add_u32 s66, s79, 163840
  buffer_load_dwordx4 v3, s[24:27], s66 offen lds
L_x7_18:
  s_lshr_b32 s66, s46, 2
  s_cmp_lg_u32 s66, 0
  s_cbranch_scc1 L_sl_19
  s_mov_b32 s70, 0
L_sp_20:
  ds_read_b128 v[232:235], v236 offset:0
  s_add_u32 s70, s70, 1
  s_waitcnt lgkmcnt(0)
  v_min_u32 v232, v232, v233
  v_min3_u32 v232, v232, v234, v235
  v_cmp_gt_u32 vcc, 1, v232
  s_cmp_lt_u32 s70, 0x400000
  s_cbranch_vccz L_spd_21
  s_sleep 1
  s_cbranch_scc1 L_sp_20
L_spd_21:
  ds_read_b128 v[32:35], v64
  ds_read_b128 v[36:39], v65
  v_add_u32 v64, s78, v64
  v_add_u32 v65, s78, v65
  ds_read_b128 v[40:43], v64
  ds_read_b128 v[44:47], v65
  v_add_u32 v64, s78, v64
  v_add_u32 v65, s78, v65
  ds_read_b128 v[48:51], v64
  ds_read_b128 v[52:55], v65
  v_add_u32 v64, s78, v64
  v_add_u32 v65, s78, v65
  ds_read_b128 v[56:59], v64
  ds_read_b128 v[60:63], v65
  s_waitcnt lgkmcnt(0)
L_sl_19:
  s_add_u32 s68, s3, 2
  s_and_b32 s68, s68, 7
  s_lshl_b32 s79, s68, 7
  s_mul_i32 s88, s68, s86
  s_add_u32 s67, s88, s87
  s_bitcmp1_b32 s46, 1
  s_cbranch_scc1 L_ha_22
  s_add_u32 m0, s80, 102400
  s_nop 0
  buffer_load_dwordx4 v4, s[28:31], s88 offen lds
  s_add_u32 m0, s81, 102400
  s_nop 0
  buffer_load_dwordx4 v5, s[28:31], s88 offen lds
  s_add_u32 m0, s82, 102400
  s_nop 0
  buffer_load_dwordx4 v6, s[28:31], s88 offen lds
  s_branch L_hb_23
L_ha_22:
  s_add_u32 m0, s83, 102400
  s_nop 0
  buffer_load_dwordx4 v4, s[32:35], s67 offen lds
  s_add_u32 m0, s84, 102400
  s_nop 0
  buffer_load_dwordx4 v5, s[32:35], s67 offen lds
  s_add_u32 m0, s85, 102400
  s_nop 0
  buffer_load_dwordx4 v6, s[32:35], s67 offen lds
L_hb_23:
  s_bitcmp1_b32 s46, 0
  s_cbranch_scc1 L_ha_24
  s_add_u32 m0, s76, 102400
  s_nop 0
  buffer_load_dwordx4 v2, s[24:27], s79 offen lds
  s_add_u32 m0, s76, 106496
  s_nop 0
  buffer_load_dwordx4 v3, s[24:27], s79 offen lds
  s_add_u32 m0, s76, 110592
  s_add_u32 s66, s79, 32768
  buffer_load_dwordx4 v3, s[24:27], s66 offen lds
  s_branch L_hb_25
L_ha_24:
  s_add_u32 m0, s76, 114688
  s_add_u32 s66, s79, 65536
  buffer_load_dwordx4 v3, s[24:27], s66 offen lds
  s_add_u32 m0, s76, 118784
  s_add_u32 s66, s79, 98304
  buffer_load_dwordx4 v3, s[24:27], s66 offen lds
  s_add_u32 m0, s76, 122880
  s_add_u32 s66, s79, 131072
  buffer_load_dwordx4 v3, s[24:27], s66 offen lds
L_hb_25:
  s_waitcnt vmcnt(6)
  v_mov_b32 v237, 2
  ds_write_b32 v238, v237
  s_bitcmp0_b32 s46, 1
  s_cbranch_scc1 L_ha_26
  s_add_u32 m0, s80, 102400
  s_nop 0
  buffer_load_dwordx4 v4, s[28:31], s88 offen lds
  s_add_u32 m0, s81, 102400
  s_nop 0
  buffer_load_dwordx4 v5, s[28:31], s88 offen lds
  s_add_u32 m0, s82, 102400
  s_nop 0
  buffer_load_dwordx4 v6, s[28:31], s88 offen lds
  s_branch L_hb_27
L_ha_26:
  s_add_u32 m0, s83, 102400
  s_nop 0
  buffer_load_dwordx4 v4, s[32:35], s67 offen lds
  s_add_u32 m0, s84, 102400
  s_nop 0
  buffer_load_dwordx4 v5, s[32:35], s67 offen lds
  s_add_u32 m0, s85, 102400
  s_nop 0
  buffer_load_dwordx4 v6, s[32:35], s67 offen lds
L_hb_27:
  s_bitcmp0_b32 s46, 0
  s_cbranch_scc1 L_ha_28
  s_add_u32 m0, s76, 102400
  s_nop 0
  buffer_load_dwordx4 v2, s[24:27], s79 offen lds
  s_add_u32 m0, s76, 106496
  s_nop 0
  buffer_load_dwordx4 v3, s[24:27], s79 offen lds
  s_add_u32 m0, s76, 110592
  s_add_u32 s66, s79, 32768
  buffer_load_dwordx4 v3, s[24:27], s66 offen lds
  s_branch L_hb_29
L_ha_28:
  s_add_u32 m0, s76, 114688
  s_add_u32 s66, s79, 65536
  buffer_load_dwordx4 v3, s[24:27], s66 offen lds
  s_add_u32 m0, s76, 118784
  s_add_u32 s66, s79, 98304
  buffer_load_dwordx4 v3, s[24:27], s66 offen lds
  s_add_u32 m0, s76, 122880
  s_add_u32 s66, s79, 131072
  buffer_load_dwordx4 v3, s[24:27], s66 offen lds
L_hb_29:
  s_cmp_eq_u32 s77, 0
  s_cbranch_scc1 L_x7_30
  s_add_u32 m0, s76, 126976
  s_add_u32 s66, s79, 163840
  buffer_load_dwordx4 v3, s[24:27], s66 offen lds
L_x7_30:
  v_mov_b32 v18, 0
  global_load_dwordx2 v[16:17], v18, s[20:21] sc1
  s_lshr_b32 s66, s46, 2
  s_cmp_lg_u32 s66, 1
  s_cbranch_scc1 L_sl_31
  s_mov_b32 s70, 0
L_sp_32:
  ds_read_b128 v[232:235], v236 offset:0
  s_add_u32 s70, s70, 1
  s_waitcnt lgkmcnt(0)
  v_min_u32 v232, v232, v233
  v_min3_u32 v232, v232, v234, v235
  v_cmp_gt_u32 vcc, 2, v232
  s_cmp_lt_u32 s70, 0x400000
  s_cbranch_vccz L_spd_33
  s_sleep 1
  s_cbranch_scc1 L_sp_32
L_spd_33:
  v_add_u32 v64, 51200, v64
  v_add_u32 v65, 51200, v65
  ds_read_b128 v[32:35], v64
  ds_read_b128 v[36:39], v65
  v_add_u32 v64, s78, v64
  v_add_u32 v65, s78, v65
  ds_read_b128 v[40:43], v64
  ds_read_b128 v[44:47], v65
  v_add_u32 v64, s78, v64
  v_add_u32 v65, s78, v65
  ds_read_b128 v[48:51], v64
  ds_read_b128 v[52:55], v65
  v_add_u32 v64, s78, v64
  v_add_u32 v65, s78, v65
  ds_read_b128 v[56:59], v64
  ds_read_b128 v[60:63], v65
  s_waitcnt lgkmcnt(0)
L_sl_31:
  ds_read_b128 v[232:235], v236 offset:16
  s_mov_b32 s70, 0
  s_waitcnt lgkmcnt(0)
  v_min_u32 v232, v232, v233
  v_min3_u32 v232, v232, v234, v235
  v_cmp_gt_u32 vcc, 1, v232
  s_nop 0
  s_cbranch_vccz L_adv_34
  s_waitcnt vmcnt(1)
  v_mov_b32 v237, 3
  ds_write_b32 v238, v237
  s_mov_b32 s70, 0
L_sp_35:
  ds_read_b128 v[232:235], v236 offset:16
  s_add_u32 s70, s70, 1
  s_waitcnt lgkmcnt(0)
  v_min_u32 v232, v232, v233
  v_min3_u32 v232, v232, v234, v235
  v_cmp_gt_u32 vcc, 1, v232
  s_cmp_lt_u32 s70, 0x400000
  s_cbranch_vccz L_spd_36
  s_sleep 1
  s_cbranch_scc1 L_sp_35
L_spd_36:
L_adv_34:
  s_mov_b32 s70, 0
L_sp_37:
  ds_read_b128 v[232:235], v236 offset:0
  s_add_u32 s70, s70, 1
  s_waitcnt lgkmcnt(0)
  v_min_u32 v232, v232, v233
  v_min3_u32 v232, v232, v234, v235
  v_cmp_gt_u32 vcc, 2, v232
  s_cmp_lt_u32 s70, 0x400000
  s_cbranch_vccz L_spd_38
  s_sleep 1
  s_cbranch_scc1 L_sp_37
L_spd_38:
  s_add_u32 s68, s3, 3
  s_and_b32 s68, s68, 7
  s_lshl_b32 s79, s68, 7
  s_mul_i32 s88, s68, s86
  s_add_u32 s67, s88, s87
  s_add_u32 m0, s80, 0
  s_nop 0
  buffer_load_dwordx4 v4, s[28:31], s88 offen lds
  s_add_u32 m0, s81, 0
  s_nop 0
  buffer_load_dwordx4 v5, s[28:31], s88 offen lds
  s_waitcnt vmcnt(3)
  v_mov_b32 v237, 3
  ds_write_b32 v238, v237
  s_add_u32 m0, s82, 0
  s_nop 0
  buffer_load_dwordx4 v6, s[28:31], s88 offen lds
  s_add_u32 m0, s83, 0
  s_nop 0
  buffer_load_dwordx4 v4, s[32:35], s67 offen lds
  s_add_u32 m0, s84, 0
  s_nop 0
  buffer_load_dwordx4 v5, s[32:35], s67 offen lds
  s_add_u32 m0, s85, 0
  s_nop 0
  buffer_load_dwordx4 v6, s[32:35], s67 offen lds
  s_add_u32 m0, s76, 0
  s_nop 0
  buffer_load_dwordx4 v2, s[24:27], s79 offen lds
  s_add_u32 m0, s76, 4096
  s_nop 0
  buffer_load_dwordx4 v3, s[24:27], s79 offen lds
  s_add_u32 m0, s76, 8192
  s_add_u32 s66, s79, 32768
  buffer_load_dwordx4 v3, s[24:27], s66 offen lds
  s_add_u32 m0, s76, 12288
  s_add_u32 s66, s79, 65536
  buffer_load_dwordx4 v3, s[24:27], s66 offen lds
  s_add_u32 m0, s76, 16384
  s_add_u32 s66, s79, 98304
  buffer_load_dwordx4 v3, s[24:27], s66 offen lds
  s_add_u32 m0, s76, 20480
  s_add_u32 s66, s79, 131072
  buffer_load_dwordx4 v3, s[24:27], s66 offen lds
  s_cmp_eq_u32 s77, 0
  s_cbranch_scc1 L_x7_39
  s_add_u32 m0, s76, 24576
  s_add_u32 s66, s79, 163840
  buffer_load_dwordx4 v3, s[24:27], s66 offen lds
L_x7_39:
  s_and_b32 s66, s2, 7
  s_lshr_b32 s67, s63, 1
  s_lshl_b32 s67, s67, 3
  s_add_u32 s66, s66, s67
  s_and_b32 s67, s63, 1
  s_lshl_b32 s67, s67, 2
  s_add_u32 s67, s67, s60
  s_lshl_b32 s68, s67, 7
  s_add_u32 s73, s68, s66
  s_cmp_lt_u32 s66, 32
  s_cselect_b32 s52, s8, s16
  s_cselect_b32 s53, s9, s17
  s_mov_b32 s54, 1409024
  s_cmov_b32 s54, 524288
  s_mov_b32 s55, 0x20000
  s_cselect_b32 s69, 0, 32
  s_sub_u32 s66, s66, s69
  s_lshl_b32 s66, s66, 14
  s_add_u32 s66, s66, s68
  s_add_u32 s67, s66, 8192
  s_mov_b32 s68, 153600
  s_cmp_ge_u32 s60, 1
  s_cmov_b32 s68, 155648
  s_cmp_ge_u32 s60, 2
  s_cmov_b32 s68, 159744
  s_cmp_ge_u32 s60, 3
  s_cmov_b32 s68, 161792
  s_mov_b32 m0, s68
  s_cmp_eq_u32 s69, 0
  buffer_load_dwordx4 v247, s[52:55], s66 offen nt lds
  s_add_u32 m0, s68, 1024
  s_cmp_eq_u32 s69, 0
  buffer_load_dwordx4 v247, s[52:55], s67 offen nt lds
  v_lshrrev_b32 v112, 5, v254
  v_lshlrev_b32 v112, 10, v112
  v_bfe_u32 v113, v254, 2, 1
  v_lshl_add_u32 v112, v113, 7, v112
  v_bfe_u32 v113, v254, 3, 1
  v_lshl_add_u32 v112, v113, 6, v112
  v_bfe_u32 v113, v254, 4, 1
  v_lshl_add_u32 v112, v113, 5, v112
  v_and_b32 v113, 3, v254
  v_lshl_add_u32 v112, v113, 3, v112
  v_add_u32 v112, s68, v112
  v_add_u32 v113, 512, v112
  s_waitcnt vmcnt(14)
  s_mov_b32 s70, 0
L_np_40:
  v_readfirstlane_b32 s64, v16
  v_readfirstlane_b32 s65, v17
  s_add_u32 s70, s70, 1
  s_add_u32 s66, s64, 800
  s_addc_u32 s67, s65, 0
  s_sub_u32 s66, s66, s44
  s_subb_u32 s67, s67, s45
  s_cmp_eq_u32 s67, 0
  s_cbranch_scc1 L_npd_41
  s_memrealtime s[66:67]
  s_cmp_eq_u64 s[64:65], 0
  s_waitcnt lgkmcnt(0)
  s_cbranch_scc1 L_npr_42
  s_sub_u32 s66, s66, s44
  s_cmp_gt_u32 s66, 3000
  s_cbranch_scc1 L_npd_41
L_npr_42:
  s_sleep 8
  global_load_dwordx2 v[16:17], v18, s[20:21] sc1
  s_waitcnt vmcnt(0)
  s_cmp_lt_u32 s70, 0x20000
  s_cbranch_scc1 L_np_40
L_npd_41:
  s_mul_i32 s66, s60, 24
  s_add_u32 s66, s66, 158976
  v_min_u32 v72, 2, v254
  v_lshl_add_u32 v73, v72, 3, s66
  ds_read_b64 v[76:77], v73
  s_mul_i32 s66, s57, 192
  s_mul_i32 s67, s58, 12
  s_add_u32 s66, s66, s67
  s_mul_i32 s67, s60, 3
  s_add_u32 s66, s66, s67
  s_lshl_b32 s66, s66, 4
  s_add_u32 s66, s66, 8388608
  s_cmp_lt_u32 s58, 16
  s_cselect_b32 s66, s66, 2130706432
  v_lshlrev_b32 v72, 4, v72
  v_mov_b32 v78, s64
  v_mov_b32 v79, s65
  s_waitcnt lgkmcnt(0)
  buffer_store_dwordx4 v[76:79], v72, s[36:39], s66 offen sc1
  s_lshr_b32 s66, s46, 2
  s_cmp_lg_u32 s66, 2
  s_cbranch_scc1 L_sl_43
  s_mov_b32 s70, 0
L_sp_44:
  ds_read_b128 v[232:235], v236 offset:0
  s_add_u32 s70, s70, 1
  s_waitcnt lgkmcnt(0)
  v_min_u32 v232, v232, v233
  v_min3_u32 v232, v232, v234, v235
  v_cmp_gt_u32 vcc, 3, v232
  s_cmp_lt_u32 s70, 0x400000
  s_cbranch_vccz L_spd_45
  s_sleep 1
  s_cbranch_scc1 L_sp_44
L_spd_45:
  v_add_u32 v64, 102400, v64
  v_add_u32 v65, 102400, v65
  ds_read_b128 v[32:35], v64
  ds_read_b128 v[36:39], v65
  v_add_u32 v64, s78, v64
  v_add_u32 v65, s78, v65
  ds_read_b128 v[40:43], v64
  ds_read_b128 v[44:47], v65
  v_add_u32 v64, s78, v64
  v_add_u32 v65, s78, v65
  ds_read_b128 v[48:51], v64
  ds_read_b128 v[52:55], v65
  v_add_u32 v64, s78, v64
  v_add_u32 v65, s78, v65
  ds_read_b128 v[56:59], v64
  ds_read_b128 v[60:63], v65
  s_waitcnt lgkmcnt(0)
L_sl_43:
  ds_read_b128 v[232:235], v236 offset:16
  s_mov_b32 s70, 0
  s_waitcnt lgkmcnt(0)
  v_min_u32 v232, v232, v233
  v_min3_u32 v232, v232, v234, v235
  v_cmp_gt_u32 vcc, 2, v232
  s_nop 0
  s_cbranch_vccz L_adv_46
  s_waitcnt vmcnt(3)
  v_mov_b32 v237, 4
  ds_write_b32 v238, v237
  s_mov_b32 s70, 0
L_sp_47:
  ds_read_b128 v[232:235], v236 offset:16
  s_add_u32 s70, s70, 1
  s_waitcnt lgkmcnt(0)
  v_min_u32 v232, v232, v233
  v_min3_u32 v232, v232, v234, v235
  v_cmp_gt_u32 vcc, 2, v232
  s_cmp_lt_u32 s70, 0x400000
  s_cbranch_vccz L_spd_48
  s_sleep 1
  s_cbranch_scc1 L_sp_47
L_spd_48:
L_adv_46:
  s_mov_b32 s70, 0
L_sp_49:
  ds_read_b128 v[232:235], v236 offset:0
  s_add_u32 s70, s70, 1
  s_waitcnt lgkmcnt(0)
  v_min_u32 v232, v232, v233
  v_min3_u32 v232, v232, v234, v235
  v_cmp_gt_u32 vcc, 3, v232
  s_cmp_lt_u32 s70, 0x400000
  s_cbranch_vccz L_spd_50
  s_sleep 1
  s_cbranch_scc1 L_sp_49
L_spd_50:
  s_add_u32 s68, s3, 4
  s_and_b32 s68, s68, 7
  s_lshl_b32 s79, s68, 7
  s_mul_i32 s88, s68, s86
  s_add_u32 s67, s88, s87
  s_add_u32 m0, s80, 51200
  s_nop 0
  buffer_load_dwordx4 v4, s[28:31], s88 offen lds
  s_add_u32 m0, s81, 51200
  s_nop 0
  buffer_load_dwordx4 v5, s[28:31], s88 offen lds
  s_waitcnt vmcnt(5)
  v_mov_b32 v237, 4
  ds_write_b32 v238, v237
  s_add_u32 m0, s82, 51200
  s_nop 0
  buffer_load_dwordx4 v6, s[28:31], s88 offen lds
  v_lshlrev_b32 v90, 16, v32
  v_and_b32 v91, 0xffff0000, v32
  v_lshlrev_b32 v92, 16, v33
  v_and_b32 v93, 0xffff0000, v33
  v_lshlrev_b32 v94, 16, v34
  v_and_b32 v95, 0xffff0000, v34
  v_lshlrev_b32 v96, 16, v35
  v_and_b32 v97, 0xffff0000, v35
  s_add_u32 m0, s83, 51200
  s_nop 0
  buffer_load_dwordx4 v4, s[32:35], s67 offen lds
  v_lshlrev_b32 v72, 16, v36
  v_and_b32 v73, 0xffff0000, v36
  v_add_f32 v90, v90, v72
  v_add_f32 v91, v91, v73
  v_lshlrev_b32 v72, 16, v37
  v_and_b32 v73, 0xffff0000, v37
  v_add_f32 v92, v92, v72
  v_add_f32 v93, v93, v73
  v_lshlrev_b32 v72, 16, v38
  v_and_b32 v73, 0xffff0000, v38
  v_add_f32 v94, v94, v72
  v_add_f32 v95, v95, v73
  v_lshlrev_b32 v72, 16, v39
  v_and_b32 v73, 0xffff0000, v39
  v_add_f32 v96, v96, v72
  v_add_f32 v97, v97, v73
  s_add_u32 m0, s84, 51200
  s_nop 0
  buffer_load_dwordx4 v5, s[32:35], s67 offen lds
  v_lshlrev_b32 v72, 16, v40
  v_and_b32 v73, 0xffff0000, v40
  v_add_f32 v90, v90, v72
  v_add_f32 v91, v91, v73
  v_lshlrev_b32 v72, 16, v41
  v_and_b32 v73, 0xffff0000, v41
  v_add_f32 v92, v92, v72
  v_add_f32 v93, v93, v73
  v_lshlrev_b32 v72, 16, v42
  v_and_b32 v73, 0xffff0000, v42
  v_add_f32 v94, v94, v72
  v_add_f32 v95, v95, v73
  v_lshlrev_b32 v72, 16, v43
  v_and_b32 v73, 0xffff0000, v43
  v_add_f32 v96, v96, v72
  v_add_f32 v97, v97, v73
  s_add_u32 m0, s85, 51200
  s_nop 0
  buffer_load_dwordx4 v6, s[32:35], s67 offen lds
  v_lshlrev_b32 v72, 16, v44
  v_and_b32 v73, 0xffff0000, v44
  v_add_f32 v90, v90, v72
  v_add_f32 v91, v91, v73
  v_lshlrev_b32 v72, 16, v45
  v_and_b32 v73, 0xffff0000, v45
  v_add_f32 v92, v92, v72
  v_add_f32 v93, v93, v73
  v_lshlrev_b32 v72, 16, v46
  v_and_b32 v73, 0xffff0000, v46
  v_add_f32 v94, v94, v72
  v_add_f32 v95, v95, v73
  v_lshlrev_b32 v72, 16, v47
  v_and_b32 v73, 0xffff0000, v47
  v_add_f32 v96, v96, v72
  v_add_f32 v97, v97, v73
  s_add_u32 m0, s76, 51200
  s_nop 0
  buffer_load_dwordx4 v2, s[24:27], s79 offen lds
  v_lshlrev_b32 v72, 16, v48
  v_and_b32 v73, 0xffff0000, v48
  v_add_f32 v90, v90, v72
  v_add_f32 v91, v91, v73
  v_lshlrev_b32 v72, 16, v49
  v_and_b32 v73, 0xffff0000, v49
  v_add_f32 v92, v92, v72
  v_add_f32 v93, v93, v73
  v_lshlrev_b32 v72, 16, v50
  v_and_b32 v73, 0xffff0000, v50
  v_add_f32 v94, v94, v72
  v_add_f32 v95, v95, v73
  v_lshlrev_b32 v72, 16, v51
  v_and_b32 v73, 0xffff0000, v51
  v_add_f32 v96, v96, v72
  v_add_f32 v97, v97, v73
  s_add_u32 m0, s76, 55296
  s_nop 0
  buffer_load_dwordx4 v3, s[24:27], s79 offen lds
  v_lshlrev_b32 v72, 16, v52
  v_and_b32 v73, 0xffff0000, v52
  v_add_f32 v90, v90, v72
  v_add_f32 v91, v91, v73
  v_lshlrev_b32 v72, 16, v53
  v_and_b32 v73, 0xffff0000, v53
  v_add_f32 v92, v92, v72
  v_add_f32 v93, v93, v73
  v_lshlrev_b32 v72, 16, v54
  v_and_b32 v73, 0xffff0000, v54
  v_add_f32 v94, v94, v72
  v_add_f32 v95, v95, v73
  v_lshlrev_b32 v72, 16, v55
  v_and_b32 v73, 0xffff0000, v55
  v_add_f32 v96, v96, v72
  v_add_f32 v97, v97, v73
  s_add_u32 m0, s76, 59392
  s_add_u32 s66, s79, 32768
  buffer_load_dwordx4 v3, s[24:27], s66 offen lds
  v_lshlrev_b32 v72, 16, v56
  v_and_b32 v73, 0xffff0000, v56
  v_add_f32 v90, v90, v72
  v_add_f32 v91, v91, v73
  v_lshlrev_b32 v72, 16, v57
  v_and_b32 v73, 0xffff0000, v57
  v_add_f32 v92, v92, v72
  v_add_f32 v93, v93, v73
  v_lshlrev_b32 v72, 16, v58
  v_and_b32 v73, 0xffff0000, v58
  v_add_f32 v94, v94, v72
  v_add_f32 v95, v95, v73
  v_lshlrev_b32 v72, 16, v59
  v_and_b32 v73, 0xffff0000, v59
  v_add_f32 v96, v96, v72
  v_add_f32 v97, v97, v73
  s_add_u32 m0, s76, 63488
  s_add_u32 s66, s79, 65536
  buffer_load_dwordx4 v3, s[24:27], s66 offen lds
  v_lshlrev_b32 v72, 16, v60
  v_and_b32 v73, 0xffff0000, v60
  v_add_f32 v90, v90, v72
  v_add_f32 v91, v91, v73
  v_lshlrev_b32 v72, 16, v61
  v_and_b32 v73, 0xffff0000, v61
  v_add_f32 v92, v92, v72
  v_add_f32 v93, v93, v73
  v_lshlrev_b32 v72, 16, v62
  v_and_b32 v73, 0xffff0000, v62
  v_add_f32 v94, v94, v72
  v_add_f32 v95, v95, v73
  v_lshlrev_b32 v72, 16, v63
  v_and_b32 v73, 0xffff0000, v63
  v_add_f32 v96, v96, v72
  v_add_f32 v97, v97, v73
  s_add_u32 m0, s76, 67584
  s_add_u32 s66, s79, 98304
  buffer_load_dwordx4 v3, s[24:27], s66 offen lds
  v_permlane32_swap_b32 v90, v94
  v_permlane32_swap_b32 v91, v95
  v_permlane32_swap_b32 v92, v96
  v_permlane32_swap_b32 v93, v97
  v_add_f32 v90, v90, v94
  v_add_f32 v91, v91, v95
  v_add_f32 v92, v92, v96
  v_add_f32 v93, v93, v97
  s_nop 0
  v_permlane16_swap_b32 v90, v92
  v_permlane16_swap_b32 v91, v93
  v_add_f32 v90, v90, v92
  v_add_f32 v91, v91, v93
  s_nop 0
  v_add_f32_dpp v98, v90, v90 row_ror:8 row_mask:0xf bank_mask:0xf
  v_add_f32_dpp v99, v91, v91 row_ror:8 row_mask:0xf bank_mask:0xf
  s_add_u32 m0, s76, 71680
  s_add_u32 s66, s79, 131072
  buffer_load_dwordx4 v3, s[24:27], s66 offen lds
  s_cmp_eq_u32 s77, 0
  s_cbranch_scc1 L_x7_51
  s_add_u32 m0, s76, 75776
  s_add_u32 s66, s79, 163840
  buffer_load_dwordx4 v3, s[24:27], s66 offen lds
L_x7_51:
  s_waitcnt vmcnt(13)
  ds_read_b64_tr_b16 v[104:105], v112 offset:0
  ds_read_b64_tr_b16 v[106:107], v113 offset:0
  ds_read_b64_tr_b16 v[108:109], v112 offset:256
  ds_read_b64_tr_b16 v[110:111], v113 offset:256
  s_lshl_b32 s66, s73, 11
  s_add_u32 s66, s66, 10485760
  s_waitcnt lgkmcnt(0)
  buffer_store_dwordx4 v[104:107], v7, s[36:39], s66 offen sc1
  buffer_store_dwordx4 v[108:111], v7, s[36:39], s66 offen offset:1024 sc1
  v_mov_b32 v100, s64
  v_mov_b32 v101, s65
  v_lshrrev_b32 v72, 4, v254
  v_lshl_add_u32 v72, v9, 2, v72
  v_lshlrev_b32 v72, 4, v72
  v_and_b32 v73, 8, v254
  v_cmp_eq_u32 vcc, 0, v73
  v_mov_b32 v73, 2130706432
  s_nop 0
  v_cndmask_b32 v72, v73, v72, vcc
  s_lshl_b32 s66, s58, 14
  s_lshr_b32 s67, s46, 2
  s_add_u32 s67, s67, s3
  s_and_b32 s67, s67, 7
  s_lshl_b32 s67, s67, 11
  s_add_u32 s66, s66, s67
  s_lshl_b32 s67, s60, 9
  s_add_u32 s66, s66, s67
  s_add_u32 s66, s66, 8454144
  buffer_store_dwordx4 v[98:101], v72, s[36:39], s66 offen sc1
  ds_read_b128 v[232:235], v236 offset:16
  s_mov_b32 s70, 0
  s_waitcnt lgkmcnt(0)
  v_min_u32 v232, v232, v233
  v_min3_u32 v232, v232, v234, v235
  v_cmp_gt_u32 vcc, 3, v232
  s_nop 0
  s_cbranch_vccz L_adv_52
  s_waitcnt vmcnt(3)
  v_mov_b32 v237, 5
  ds_write_b32 v238, v237
  s_mov_b32 s70, 0
L_sp_53:
  ds_read_b128 v[232:235], v236 offset:16
  s_add_u32 s70, s70, 1
  s_waitcnt lgkmcnt(0)
  v_min_u32 v232, v232, v233
  v_min3_u32 v232, v232, v234, v235
  v_cmp_gt_u32 vcc, 3, v232
  s_cmp_lt_u32 s70, 0x400000
  s_cbranch_vccz L_spd_54
  s_sleep 1
  s_cbranch_scc1 L_sp_53
L_spd_54:
L_adv_52:
  s_mov_b32 s70, 0
L_sp_55:
  ds_read_b128 v[232:235], v236 offset:0
  s_add_u32 s70, s70, 1
  s_waitcnt lgkmcnt(0)
  v_min_u32 v232, v232, v233
  v_min3_u32 v232, v232, v234, v235
  v_cmp_gt_u32 vcc, 4, v232
  s_cmp_lt_u32 s70, 0x400000
  s_cbranch_vccz L_spd_56
  s_sleep 1
  s_cbranch_scc1 L_sp_55
L_spd_56:
  s_add_u32 s68, s3, 5
  s_and_b32 s68, s68, 7
  s_lshl_b32 s79, s68, 7
  s_mul_i32 s88, s68, s86
  s_add_u32 s67, s88, s87
  s_add_u32 m0, s80, 102400
  s_nop 0
  buffer_load_dwordx4 v4, s[28:31], s88 offen lds
  s_add_u32 m0, s81, 102400
  s_nop 0
  buffer_load_dwordx4 v5, s[28:31], s88 offen lds
  s_waitcnt vmcnt(5)
  v_mov_b32 v237, 5
  ds_write_b32 v238, v237
  s_add_u32 m0, s82, 102400
  s_nop 0
  buffer_load_dwordx4 v6, s[28:31], s88 offen lds
  s_add_u32 m0, s83, 102400
  s_nop 0
  buffer_load_dwordx4 v4, s[32:35], s67 offen lds
  s_add_u32 m0, s84, 102400
  s_nop 0
  buffer_load_dwordx4 v5, s[32:35], s67 offen lds
  s_add_u32 m0, s85, 102400
  s_nop 0
  buffer_load_dwordx4 v6, s[32:35], s67 offen lds
  s_add_u32 m0, s76, 102400
  s_nop 0
  buffer_load_dwordx4 v2, s[24:27], s79 offen lds
  s_add_u32 m0, s76, 106496
  s_nop 0
  buffer_load_dwordx4 v3, s[24:27], s79 offen lds
  s_add_u32 m0, s76, 110592
  s_add_u32 s66, s79, 32768
  buffer_load_dwordx4 v3, s[24:27], s66 offen lds
  s_add_u32 m0, s76, 114688
  s_add_u32 s66, s79, 65536
  buffer_load_dwordx4 v3, s[24:27], s66 offen lds
  s_add_u32 m0, s76, 118784
  s_add_u32 s66, s79, 98304
  buffer_load_dwordx4 v3, s[24:27], s66 offen lds
  s_add_u32 m0, s76, 122880
  s_add_u32 s66, s79, 131072
  buffer_load_dwordx4 v3, s[24:27], s66 offen lds
  s_cmp_eq_u32 s77, 0
  s_cbranch_scc1 L_x7_57
  s_add_u32 m0, s76, 126976
  s_add_u32 s66, s79, 163840
  buffer_load_dwordx4 v3, s[24:27], s66 offen lds
L_x7_57:
  s_waitcnt vmcnt(13)
  s_lshl_b32 s66, s73, 4
  s_add_u32 s66, s66, 8978432
  v_mov_b32 v104, s64
  v_mov_b32 v105, s65
  v_mov_b32 v106, 0
  buffer_store_dwordx2 v[104:105], v106, s[36:39], s66 offen sc1
  ds_read_b128 v[232:235], v236 offset:16
  s_mov_b32 s70, 0
  s_waitcnt lgkmcnt(0)
  v_min_u32 v232, v232, v233
  v_min3_u32 v232, v232, v234, v235
  v_cmp_gt_u32 vcc, 4, v232
  s_nop 0
  s_cbranch_vccz L_adv_58
  s_waitcnt vmcnt(1)
  v_mov_b32 v237, 6
  ds_write_b32 v238, v237
  s_mov_b32 s70, 0
L_sp_59:
  ds_read_b128 v[232:235], v236 offset:16
  s_add_u32 s70, s70, 1
  s_waitcnt lgkmcnt(0)
  v_min_u32 v232, v232, v233
  v_min3_u32 v232, v232, v234, v235
  v_cmp_gt_u32 vcc, 4, v232
  s_cmp_lt_u32 s70, 0x400000
  s_cbranch_vccz L_spd_60
  s_sleep 1
  s_cbranch_scc1 L_sp_59
L_spd_60:
L_adv_58:
  s_add_u32 s68, s3, 6
  s_and_b32 s68, s68, 7
  s_lshl_b32 s79, s68, 7
  s_mul_i32 s88, s68, s86
  s_add_u32 s67, s88, s87
  s_add_u32 m0, s80, 0
  s_nop 0
  buffer_load_dwordx4 v4, s[28:31], s88 offen lds
  s_add_u32 m0, s81, 0
  s_nop 0
  buffer_load_dwordx4 v5, s[28:31], s88 offen lds
  s_waitcnt vmcnt(3)
  v_mov_b32 v237, 6
  ds_write_b32 v238, v237
  s_add_u32 m0, s82, 0
  s_nop 0
  buffer_load_dwordx4 v6, s[28:31], s88 offen lds
  s_add_u32 m0, s83, 0
  s_nop 0
  buffer_load_dwordx4 v4, s[32:35], s67 offen lds
  s_add_u32 m0, s84, 0
  s_nop 0
  buffer_load_dwordx4 v5, s[32:35], s67 offen lds
  s_add_u32 m0, s85, 0
  s_nop 0
  buffer_load_dwordx4 v6, s[32:35], s67 offen lds
  s_add_u32 m0, s76, 0
  s_nop 0
  buffer_load_dwordx4 v2, s[24:27], s79 offen lds
  s_add_u32 m0, s76, 4096
  s_nop 0
  buffer_load_dwordx4 v3, s[24:27], s79 offen lds
  s_add_u32 m0, s76, 8192
  s_add_u32 s66, s79, 32768
  buffer_load_dwordx4 v3, s[24:27], s66 offen lds
  s_add_u32 m0, s76, 12288
  s_add_u32 s66, s79, 65536
  buffer_load_dwordx4 v3, s[24:27], s66 offen lds
  s_add_u32 m0, s76, 16384
  s_add_u32 s66, s79, 98304
  buffer_load_dwordx4 v3, s[24:27], s66 offen lds
  s_add_u32 m0, s76, 20480
  s_add_u32 s66, s79, 131072
  buffer_load_dwordx4 v3, s[24:27], s66 offen lds
  s_cmp_eq_u32 s77, 0
  s_cbranch_scc1 L_x7_61
  s_add_u32 m0, s76, 24576
  s_add_u32 s66, s79, 163840
  buffer_load_dwordx4 v3, s[24:27], s66 offen lds
L_x7_61:
  ds_read_b128 v[232:235], v236 offset:16
  s_mov_b32 s70, 0
  s_waitcnt lgkmcnt(0)
  v_min_u32 v232, v232, v233
  v_min3_u32 v232, v232, v234, v235
  v_cmp_gt_u32 vcc, 5, v232
  s_nop 0
  s_cbranch_vccz L_adv_62
  s_waitcnt vmcnt(0)
  v_mov_b32 v237, 7
  ds_write_b32 v238, v237
  s_mov_b32 s70, 0
L_sp_63:
  ds_read_b128 v[232:235], v236 offset:16
  s_add_u32 s70, s70, 1
  s_waitcnt lgkmcnt(0)
  v_min_u32 v232, v232, v233
  v_min3_u32 v232, v232, v234, v235
  v_cmp_gt_u32 vcc, 5, v232
  s_cmp_lt_u32 s70, 0x400000
  s_cbranch_vccz L_spd_64
  s_sleep 1
  s_cbranch_scc1 L_sp_63
L_spd_64:
L_adv_62:
  s_add_u32 s68, s3, 7
  s_and_b32 s68, s68, 7
  s_lshl_b32 s79, s68, 7
  s_mul_i32 s88, s68, s86
  s_add_u32 s67, s88, s87
  s_add_u32 m0, s80, 51200
  s_nop 0
  buffer_load_dwordx4 v4, s[28:31], s88 offen lds
  s_add_u32 m0, s81, 51200
  s_nop 0
  buffer_load_dwordx4 v5, s[28:31], s88 offen lds
  s_waitcnt vmcnt(2)
  v_mov_b32 v237, 7
  ds_write_b32 v238, v237
  s_add_u32 m0, s82, 51200
  s_nop 0
  buffer_load_dwordx4 v6, s[28:31], s88 offen lds
  s_add_u32 m0, s83, 51200
  s_nop 0
  buffer_load_dwordx4 v4, s[32:35], s67 offen lds
  s_add_u32 m0, s84, 51200
  s_nop 0
  buffer_load_dwordx4 v5, s[32:35], s67 offen lds
  s_add_u32 m0, s85, 51200
  s_nop 0
  buffer_load_dwordx4 v6, s[32:35], s67 offen lds
  s_add_u32 m0, s76, 51200
  s_nop 0
  buffer_load_dwordx4 v2, s[24:27], s79 offen lds
  s_add_u32 m0, s76, 55296
  s_nop 0
  buffer_load_dwordx4 v3, s[24:27], s79 offen lds
  s_add_u32 m0, s76, 59392
  s_add_u32 s66, s79, 32768
  buffer_load_dwordx4 v3, s[24:27], s66 offen lds
  s_add_u32 m0, s76, 63488
  s_add_u32 s66, s79, 65536
  buffer_load_dwordx4 v3, s[24:27], s66 offen lds
  s_add_u32 m0, s76, 67584
  s_add_u32 s66, s79, 98304
  buffer_load_dwordx4 v3, s[24:27], s66 offen lds
  s_add_u32 m0, s76, 71680
  s_add_u32 s66, s79, 131072
  buffer_load_dwordx4 v3, s[24:27], s66 offen lds
  s_cmp_eq_u32 s77, 0
  s_cbranch_scc1 L_x7_65
  s_add_u32 m0, s76, 75776
  s_add_u32 s66, s79, 163840
  buffer_load_dwordx4 v3, s[24:27], s66 offen lds
L_x7_65:
  buffer_load_dwordx4 v[20:23], v200, s[36:39], 0 offen offset:0 sc1
  buffer_load_dwordx4 v[24:27], v200, s[36:39], 0 offen offset:2048 sc1
  s_movk_i32 s66, 4096
  buffer_load_dwordx4 v[28:31], v200, s[36:39], s66 offen sc1
  s_movk_i32 s66, 6144
  buffer_load_dwordx4 v[32:35], v200, s[36:39], s66 offen sc1
  buffer_load_dwordx4 v[36:39], v201, s[36:39], 0 offen sc1
  buffer_load_dwordx2 v[40:41], v206, s[36:39], 0 offen sc1
  s_waitcnt vmcnt(6)
  v_mov_b32 v237, 8
  ds_write_b32 v238, v237
  s_waitcnt vmcnt(0)
  v_cmp_eq_u64 vcc, s[64:65], v[38:39]
  s_nop 0
  s_orn2_b64 s[68:69], vcc, s[74:75]
  v_cmp_eq_u64 vcc, s[64:65], v[22:23]
  s_nop 0
  s_and_b64 s[68:69], s[68:69], vcc
  v_cmp_eq_u64 vcc, s[64:65], v[26:27]
  s_nop 0
  s_and_b64 s[68:69], s[68:69], vcc
  v_cmp_eq_u64 vcc, s[64:65], v[30:31]
  s_nop 0
  s_and_b64 s[68:69], s[68:69], vcc
  v_cmp_eq_u64 vcc, s[64:65], v[34:35]
  s_nop 0
  s_and_b64 s[68:69], s[68:69], vcc
  s_cmp_eq_u64 s[68:69], -1
  s_cbranch_scc1 L_clok_66
  s_mov_b32 s70, 0
L_clre_67:
  s_sleep 4
  buffer_load_dwordx4 v[20:23], v200, s[36:39], 0 offen offset:0 sc1
  buffer_load_dwordx4 v[24:27], v200, s[36:39], 0 offen offset:2048 sc1
  s_movk_i32 s66, 4096
  buffer_load_dwordx4 v[28:31], v200, s[36:39], s66 offen sc1
  s_movk_i32 s66, 6144
  buffer_load_dwordx4 v[32:35], v200, s[36:39], s66 offen sc1
  buffer_load_dwordx4 v[36:39], v201, s[36:39], 0 offen sc1
  s_waitcnt vmcnt(0)
  s_add_u32 s70, s70, 1
  v_cmp_eq_u64 vcc, s[64:65], v[38:39]
  s_nop 0
  s_orn2_b64 s[68:69], vcc, s[74:75]
  v_cmp_eq_u64 vcc, s[64:65], v[22:23]
  s_nop 0
  s_and_b64 s[68:69], s[68:69], vcc
  v_cmp_eq_u64 vcc, s[64:65], v[26:27]
  s_nop 0
  s_and_b64 s[68:69], s[68:69], vcc
  v_cmp_eq_u64 vcc, s[64:65], v[30:31]
  s_nop 0
  s_and_b64 s[68:69], s[68:69], vcc
  v_cmp_eq_u64 vcc, s[64:65], v[34:35]
  s_nop 0
  s_and_b64 s[68:69], s[68:69], vcc
  s_cmp_eq_u64 s[68:69], -1
  s_cbranch_scc1 L_clok_66
  s_cmp_lt_u32 s70, 0x20000
  s_cbranch_scc1 L_clre_67
L_clok_66:
  v_add_f32 v20, v20, v24
  v_add_f32 v21, v21, v25
  v_add_f32 v28, v28, v32
  v_add_f32 v29, v29, v33
  v_add_f32 v20, v20, v28
  v_add_f32 v21, v21, v29
  v_cndmask_b32 v36, 0, v36, s[74:75]
  v_cndmask_b32 v38, 1.0, v37, s[74:75]
  v_mov_b32 v22, v20
  v_mov_b32 v23, v21
  v_rsq_f32 v37, v38
  s_cmp_eq_u32 s59, 1
  s_mov_b32 s66, 0xbfb8aa3b
  s_cmov_b32 s66, 0x3eb8aa3b
  v_permlane32_swap_b32 v20, v22
  v_permlane32_swap_b32 v21, v23
  v_mul_f32 v39, s66, v37
  v_add_f32 v20, v20, v22
  v_add_f32 v21, v21, v23
  ds_write_b128 v204, v[36:39]
  ds_write_b32 v205, v36
  ds_write_b32 v205, v37 offset:1024
  ds_write_b64 v203, v[20:21]
  ds_write_b64 v236, v[16:17] offset:32
  s_waitcnt lgkmcnt(0)
  v_mov_b32 v237, 9
  ds_write_b32 v238, v237
  s_mov_b32 s70, 0
L_pkre_69:
  v_cmp_eq_u64 vcc, s[64:65], v[40:41]
  s_nop 0
  s_cmp_eq_u64 vcc, -1
  s_cbranch_scc1 L_pkok_68
  s_sleep 4
  buffer_load_dwordx2 v[40:41], v206, s[36:39], 0 offen sc1
  s_add_u32 s70, s70, 1
  s_cmp_lt_u32 s70, 0x20000
  s_waitcnt vmcnt(0)
  s_cbranch_scc1 L_pkre_69
L_pkok_68:
  v_mov_b32 v237, 10
  ds_write_b32 v238, v237
  s_add_u32 s68, s91, 0
  s_cmp_ge_u32 s68, s92
  s_cselect_b32 s66, s92, 0
  s_sub_u32 s68, s68, s66
  s_add_u32 s66, s93, s68
  s_lshl_b32 s66, s66, 11
  buffer_load_dwordx4 v[64:67], v246, s[36:39], s66 offen sc1
  buffer_load_dwordx4 v[68:71], v246, s[36:39], s66 offen offset:1024 sc1
  s_add_u32 s68, s91, 1
  s_cmp_ge_u32 s68, s92
  s_cselect_b32 s66, s92, 0
  s_sub_u32 s68, s68, s66
  s_add_u32 s66, s93, s68
  s_lshl_b32 s66, s66, 11
  buffer_load_dwordx4 v[72:75], v246, s[36:39], s66 offen sc1
  buffer_load_dwordx4 v[76:79], v246, s[36:39], s66 offen offset:1024 sc1
  s_add_u32 s68, s91, 2
  s_cmp_ge_u32 s68, s92
  s_cselect_b32 s66, s92, 0
  s_sub_u32 s68, s68, s66
  s_add_u32 s66, s93, s68
  s_lshl_b32 s66, s66, 11
  buffer_load_dwordx4 v[80:83], v246, s[36:39], s66 offen sc1
  buffer_load_dwordx4 v[84:87], v246, s[36:39], s66 offen offset:1024 sc1
  s_add_u32 s68, s91, 3
  s_cmp_ge_u32 s68, s92
  s_cselect_b32 s66, s92, 0
  s_sub_u32 s68, s68, s66
  s_add_u32 s66, s93, s68
  s_lshl_b32 s66, s66, 11
  buffer_load_dwordx4 v[88:91], v246, s[36:39], s66 offen sc1
  buffer_load_dwordx4 v[92:95], v246, s[36:39], s66 offen offset:1024 sc1
  s_add_u32 s68, s91, 4
  s_cmp_ge_u32 s68, s92
  s_cselect_b32 s66, s92, 0
  s_sub_u32 s68, s68, s66
  s_add_u32 s66, s93, s68
  s_lshl_b32 s66, s66, 11
  buffer_load_dwordx4 v[96:99], v246, s[36:39], s66 offen sc1
  buffer_load_dwordx4 v[100:103], v246, s[36:39], s66 offen offset:1024 sc1
  s_add_u32 s68, s91, 5
  s_cmp_ge_u32 s68, s92
  s_cselect_b32 s66, s92, 0
  s_sub_u32 s68, s68, s66
  s_add_u32 s66, s93, s68
  s_lshl_b32 s66, s66, 11
  buffer_load_dwordx4 v[104:107], v246, s[36:39], s66 offen sc1
  buffer_load_dwordx4 v[108:111], v246, s[36:39], s66 offen offset:1024 sc1
  s_add_u32 s68, s91, 6
  s_cmp_ge_u32 s68, s92
  s_cselect_b32 s66, s92, 0
  s_sub_u32 s68, s68, s66
  s_add_u32 s66, s93, s68
  s_lshl_b32 s66, s66, 11
  buffer_load_dwordx4 v[112:115], v246, s[36:39], s66 offen sc1
  buffer_load_dwordx4 v[116:119], v246, s[36:39], s66 offen offset:1024 sc1
  s_add_u32 s68, s91, 7
  s_cmp_ge_u32 s68, s92
  s_cselect_b32 s66, s92, 0
  s_sub_u32 s68, s68, s66
  s_add_u32 s66, s93, s68
  s_lshl_b32 s66, s66, 11
  buffer_load_dwordx4 v[120:123], v246, s[36:39], s66 offen sc1
  buffer_load_dwordx4 v[124:127], v246, s[36:39], s66 offen offset:1024 sc1
  s_mov_b32 s70, 0
L_sp_70:
  ds_read_b128 v[232:235], v236 offset:16
  s_add_u32 s70, s70, 1
  s_waitcnt lgkmcnt(0)
  v_min_u32 v232, v232, v233
  v_min3_u32 v232, v232, v234, v235
  v_cmp_gt_u32 vcc, 6, v232
  s_cmp_lt_u32 s70, 0x400000
  s_cbranch_vccz L_spd_71
  s_sleep 1
  s_cbranch_scc1 L_sp_70
L_spd_71:
  s_add_u32 s68, s47, 0
  s_cmp_ge_u32 s68, s101
  s_cselect_b32 s66, s101, 0
  s_sub_u32 s68, s68, s66
  s_add_u32 s66, s100, s68
  s_lshl_b32 s66, s66, 11
  s_add_u32 m0, s95, 106496
  s_nop 0
  buffer_load_dwordx4 v246, s[36:39], s66 offen sc1 lds
  buffer_load_dwordx4 v246, s[36:39], s66 offen offset:1024 sc1 lds
  s_add_u32 s68, s47, 1
  s_cmp_ge_u32 s68, s101
  s_cselect_b32 s66, s101, 0
  s_sub_u32 s68, s68, s66
  s_add_u32 s66, s100, s68
  s_lshl_b32 s66, s66, 11
  s_add_u32 m0, s95, 114688
  s_nop 0
  buffer_load_dwordx4 v246, s[36:39], s66 offen sc1 lds
  buffer_load_dwordx4 v246, s[36:39], s66 offen offset:1024 sc1 lds
  s_add_u32 s68, s47, 2
  s_cmp_ge_u32 s68, s101
  s_cselect_b32 s66, s101, 0
  s_sub_u32 s68, s68, s66
  s_add_u32 s66, s100, s68
  s_lshl_b32 s66, s66, 11
  s_add_u32 m0, s95, 122880
  s_nop 0
  buffer_load_dwordx4 v246, s[36:39], s66 offen sc1 lds
  buffer_load_dwordx4 v246, s[36:39], s66 offen offset:1024 sc1 lds
  s_add_u32 s68, s47, 3
  s_cmp_ge_u32 s68, s101
  s_cselect_b32 s66, s101, 0
  s_sub_u32 s68, s68, s66
  s_add_u32 s66, s100, s68
  s_lshl_b32 s66, s66, 11
  s_add_u32 m0, s95, 131072
  s_nop 0
  buffer_load_dwordx4 v246, s[36:39], s66 offen sc1 lds
  buffer_load_dwordx4 v246, s[36:39], s66 offen offset:1024 sc1 lds
  s_add_u32 s68, s47, 4
  s_cmp_ge_u32 s68, s101
  s_cselect_b32 s66, s101, 0
  s_sub_u32 s68, s68, s66
  s_add_u32 s66, s100, s68
  s_lshl_b32 s66, s66, 11
  s_add_u32 m0, s95, 139264
  s_nop 0
  buffer_load_dwordx4 v246, s[36:39], s66 offen sc1 lds
  buffer_load_dwordx4 v246, s[36:39], s66 offen offset:1024 sc1 lds
  s_add_u32 s68, s47, 5
  s_cmp_ge_u32 s68, s101
  s_cselect_b32 s66, s101, 0
  s_sub_u32 s68, s68, s66
  s_add_u32 s66, s100, s68
  s_lshl_b32 s66, s66, 11
  s_add_u32 m0, s95, 147456
  s_nop 0
  buffer_load_dwordx4 v246, s[36:39], s66 offen sc1 lds
  buffer_load_dwordx4 v246, s[36:39], s66 offen offset:1024 sc1 lds
  s_add_u32 s68, s91, 8
  s_cmp_ge_u32 s68, s92
  s_cselect_b32 s66, s92, 0
  s_sub_u32 s68, s68, s66
  s_add_u32 s66, s93, s68
  s_lshl_b32 s66, s66, 11
  buffer_load_dwordx4 v[128:131], v246, s[36:39], s66 offen sc1
  buffer_load_dwordx4 v[132:135], v246, s[36:39], s66 offen offset:1024 sc1
  s_add_u32 s68, s91, 9
  s_cmp_ge_u32 s68, s92
  s_cselect_b32 s66, s92, 0
  s_sub_u32 s68, s68, s66
  s_add_u32 s66, s93, s68
  s_lshl_b32 s66, s66, 11
  buffer_load_dwordx4 v[136:139], v246, s[36:39], s66 offen sc1
  buffer_load_dwordx4 v[140:143], v246, s[36:39], s66 offen offset:1024 sc1
  s_add_u32 s68, s91, 10
  s_cmp_ge_u32 s68, s92
  s_cselect_b32 s66, s92, 0
  s_sub_u32 s68, s68, s66
  s_add_u32 s66, s93, s68
  s_lshl_b32 s66, s66, 11
  buffer_load_dwordx4 v[144:147], v246, s[36:39], s66 offen sc1
  buffer_load_dwordx4 v[148:151], v246, s[36:39], s66 offen offset:1024 sc1
  s_add_u32 s68, s91, 11
  s_cmp_ge_u32 s68, s92
  s_cselect_b32 s66, s92, 0
  s_sub_u32 s68, s68, s66
  s_add_u32 s66, s93, s68
  s_lshl_b32 s66, s66, 11
  buffer_load_dwordx4 v[152:155], v246, s[36:39], s66 offen sc1
  buffer_load_dwordx4 v[156:159], v246, s[36:39], s66 offen offset:1024 sc1
  s_mov_b32 s70, 0
L_sp_72:
  ds_read_b128 v[232:235], v236 offset:16
  s_add_u32 s70, s70, 1
  s_waitcnt lgkmcnt(0)
  v_min_u32 v232, v232, v233
  v_min3_u32 v232, v232, v234, v235
  v_cmp_gt_u32 vcc, 7, v232
  s_cmp_lt_u32 s70, 0x400000
  s_cbranch_vccz L_spd_73
  s_sleep 1
  s_cbranch_scc1 L_sp_72
L_spd_73:
  s_add_u32 s68, s47, 10
  s_cmp_ge_u32 s68, s101
  s_cselect_b32 s66, s101, 0
  s_sub_u32 s68, s68, s66
  s_add_u32 s66, s100, s68
  s_lshl_b32 s66, s66, 11
  s_add_u32 m0, s95, 24576
  s_nop 0
  buffer_load_dwordx4 v246, s[36:39], s66 offen sc1 lds
  buffer_load_dwordx4 v246, s[36:39], s66 offen offset:1024 sc1 lds
  s_add_u32 s68, s47, 11
  s_cmp_ge_u32 s68, s101
  s_cselect_b32 s66, s101, 0
  s_sub_u32 s68, s68, s66
  s_add_u32 s66, s100, s68
  s_lshl_b32 s66, s66, 11
  s_add_u32 m0, s95, 32768
  s_nop 0
  buffer_load_dwordx4 v246, s[36:39], s66 offen sc1 lds
  buffer_load_dwordx4 v246, s[36:39], s66 offen offset:1024 sc1 lds
  s_add_u32 s68, s47, 12
  s_cmp_ge_u32 s68, s101
  s_cselect_b32 s66, s101, 0
  s_sub_u32 s68, s68, s66
  s_add_u32 s66, s100, s68
  s_lshl_b32 s66, s66, 11
  s_add_u32 m0, s95, 40960
  s_nop 0
  buffer_load_dwordx4 v246, s[36:39], s66 offen sc1 lds
  buffer_load_dwordx4 v246, s[36:39], s66 offen offset:1024 sc1 lds
  s_add_u32 s68, s47, 13
  s_cmp_ge_u32 s68, s101
  s_cselect_b32 s66, s101, 0
  s_sub_u32 s68, s68, s66
  s_add_u32 s66, s100, s68
  s_lshl_b32 s66, s66, 11
  s_cmp_gt_u32 s101, 13
  s_cselect_b32 s66, s66, 2130706432
  s_add_u32 m0, s95, 0
  s_nop 0
  buffer_load_dwordx4 v246, s[36:39], s66 offen sc1 lds
  buffer_load_dwordx4 v246, s[36:39], s66 offen offset:1024 sc1 lds
  s_add_u32 s68, s47, 14
  s_cmp_ge_u32 s68, s101
  s_cselect_b32 s66, s101, 0
  s_sub_u32 s68, s68, s66
  s_add_u32 s66, s100, s68
  s_lshl_b32 s66, s66, 11
  s_cmp_gt_u32 s101, 14
  s_cselect_b32 s66, s66, 2130706432
  s_add_u32 m0, s95, 8192
  s_nop 0
  buffer_load_dwordx4 v246, s[36:39], s66 offen sc1 lds
  buffer_load_dwordx4 v246, s[36:39], s66 offen offset:1024 sc1 lds
  s_add_u32 s68, s47, 15
  s_cmp_ge_u32 s68, s101
  s_cselect_b32 s66, s101, 0
  s_sub_u32 s68, s68, s66
  s_add_u32 s66, s100, s68
  s_lshl_b32 s66, s66, 11
  s_cmp_gt_u32 s101, 15
  s_cselect_b32 s66, s66, 2130706432
  s_add_u32 m0, s95, 16384
  s_nop 0
  buffer_load_dwordx4 v246, s[36:39], s66 offen sc1 lds
  buffer_load_dwordx4 v246, s[36:39], s66 offen offset:1024 sc1 lds
  s_waitcnt vmcnt(0)
  v_mov_b32 v237, 11
  ds_write_b32 v238, v237
  s_cmp_eq_u32 s59, 1
  s_cbranch_scc1 L_NOHOLD
  s_mov_b32 s70, 0
L_sp_74:
  ds_read_b128 v[232:235], v236 offset:16
  s_add_u32 s70, s70, 1
  s_waitcnt lgkmcnt(0)
  v_min_u32 v232, v232, v233
  v_min3_u32 v232, v232, v234, v235
  v_cmp_gt_u32 vcc, 9, v232
  s_cmp_lt_u32 s70, 0x400000
  s_cbranch_vccz L_spd_75
  s_sleep 1
  s_cbranch_scc1 L_sp_74
L_spd_75:
L_NOHOLD:
  s_mov_b32 s70, 0
L_sp_76:
  ds_read_b128 v[232:235], v236 offset:16
  s_add_u32 s70, s70, 1
  s_waitcnt lgkmcnt(0)
  v_min_u32 v232, v232, v233
  v_min3_u32 v232, v232, v234, v235
  v_cmp_gt_u32 vcc, 8, v232
  s_cmp_lt_u32 s70, 0x400000
  s_cbranch_vccz L_spd_77
  s_sleep 1
  s_cbranch_scc1 L_sp_76
L_spd_77:
  s_add_u32 s68, s91, 12
  s_cmp_ge_u32 s68, s92
  s_cselect_b32 s66, s92, 0
  s_sub_u32 s68, s68, s66
  s_add_u32 s66, s93, s68
  s_lshl_b32 s66, s66, 11
  buffer_load_dwordx4 v[160:163], v246, s[36:39], s66 offen sc1
  buffer_load_dwordx4 v[164:167], v246, s[36:39], s66 offen offset:1024 sc1
  s_add_u32 s68, s91, 13
  s_cmp_ge_u32 s68, s92
  s_cselect_b32 s66, s92, 0
  s_sub_u32 s68, s68, s66
  s_add_u32 s66, s93, s68
  s_lshl_b32 s66, s66, 11
  s_cmp_gt_u32 s92, 13
  s_cselect_b32 s66, s66, 2130706432
  buffer_load_dwordx4 v[168:171], v246, s[36:39], s66 offen sc1
  buffer_load_dwordx4 v[172:175], v246, s[36:39], s66 offen offset:1024 sc1
  s_setprio 0
L_P2:
L_WP_0:
  s_cbranch_execz L_WP_1
  s_lshl_b32 s71, s56, 3
  s_mov_b32 s66, 33559311
  s_mov_b32 s67, 201918213
  s_lshr_b64 s[66:67], s[66:67], s71
  s_and_b32 s72, s66, 0xff
  s_mov_b32 s66, 50463491
  s_mov_b32 s67, 33686018
  s_lshr_b64 s[66:67], s[66:67], s71
  s_and_b32 s73, s66, 0xff
  s_mul_i32 s66, s61, 86
  s_lshr_b32 s66, s66, 8
  s_mul_i32 s66, s66, 23
  s_add_u32 s66, s66, s72
  v_lshrrev_b32 v1, 2, v254
  v_min_u32 v1, s73, v1
  v_add_u32 v1, s66, v1
  v_lshlrev_b32 v1, 7, v1
  v_and_b32 v2, 3, v254
  v_lshl_add_u32 v1, v2, 4, v1
  s_and_b32 s66, s56, 0
  s_lshl_b32 s66, s66, 4
  s_add_u32 s66, s66, 9175040
  v_add_u32 v228, s66, v1
  s_lshl_b32 s66, s56, 3
  s_lshl_b32 s67, s61, 6
  s_add_u32 s66, s66, s67
  v_lshrrev_b32 v1, 3, v254
  v_add_u32 v1, s66, v1
  v_lshlrev_b32 v1, 10, v1
  v_and_b32 v2, 7, v254
  v_lshl_add_u32 v1, v2, 4, v1
  s_lshl_b32 s66, s62, 7
  v_add_u32 v248, s66, v1
  v_add_u32 v249, 120832, v246
  s_lshl_b32 s66, s56, 14
  s_add_u32 s66, s66, 24576
  v_and_b32 v1, 31, v254
  v_lshlrev_b32 v1, 8, v1
  v_add_u32 v1, s66, v1
  v_lshrrev_b32 v2, 5, v254
  v_and_b32 v3, 7, v254
  v_xor_b32 v2, v2, v3
  v_xor_b32 v232, 0, v2
  v_lshl_add_u32 v232, v232, 4, v1
  v_xor_b32 v233, 2, v2
  v_lshl_add_u32 v233, v233, 4, v1
  v_xor_b32 v234, 4, v2
  v_lshl_add_u32 v234, v234, 4, v1
  v_xor_b32 v235, 6, v2
L_WP_1:
  s_cbranch_execz L_WP_2
  v_lshl_add_u32 v235, v235, 4, v1
  s_lshl_b32 s66, s56, 11
  s_add_u32 s66, s66, 24576
  v_lshrrev_b32 v1, 3, v254
  v_and_b32 v2, 3, v254
  v_lshlrev_b32 v2, 1, v2
  v_xor_b32 v2, v2, v1
  v_lshlrev_b32 v2, 4, v2
  v_lshl_add_u32 v2, v1, 8, v2
  v_and_b32 v1, 4, v254
  v_lshl_add_u32 v2, v1, 5, v2
  v_add_u32 v243, s66, v2
  v_xor_b32 v244, 16, v243
  v_add_u32 v245, 0x10000, v243
  v_add_u32 v247, 0x10000, v244
  v_mov_b32 v236, 159696
  s_mov_b32 s70, 0
  s_mov_b32 s52, s18
  s_mov_b32 s53, s19
  s_mov_b32 s54, 2097152
  s_mov_b32 s55, 0x20000
  s_mov_b32 exec_hi, 0
L_POLL:
  buffer_load_dwordx2 v[230:231], v228, s[36:39], 0 offen sc1
  s_add_u32 s70, s70, 1
  s_waitcnt vmcnt(0)
  v_cmp_eq_u64 vcc, s[64:65], v[230:231]
  s_nop 0
  s_cmp_eq_u64 vcc, exec
  s_cbranch_scc1 L_POLLED
  s_sleep 8
  s_cmp_lt_u32 s70, 0x20000
  s_cbranch_scc1 L_POLL
L_POLLED:
  s_mov_b64 exec, -1
  s_cmp_lt_u32 s56, 4
  s_cbranch_scc1 L_P2C
  s_add_u32 s68, s91, 0
  s_cmp_ge_u32 s68, s92
  s_cselect_b32 s66, s92, 0
  s_sub_u32 s68, s68, s66
  s_add_u32 s66, s94, s68
  s_lshl_b32 s66, s66, 10
  buffer_load_dwordx4 v[192:195], v246, s[40:43], s66 offen sc1
  buffer_load_dwordx4 v[196:199], v249, s[40:43], s66 offen sc1
  s_add_u32 s68, s91, 1
  s_cmp_ge_u32 s68, s92
  s_cselect_b32 s66, s92, 0
  s_sub_u32 s68, s68, s66
  s_add_u32 s66, s94, s68
  s_lshl_b32 s66, s66, 10
  buffer_load_dwordx4 v[200:203], v246, s[40:43], s66 offen sc1
  buffer_load_dwordx4 v[204:207], v249, s[40:43], s66 offen sc1
L_WP_2:
  s_cbranch_execz L_WP_3
  s_add_u32 s68, s91, 2
  s_cmp_ge_u32 s68, s92
  s_cselect_b32 s66, s92, 0
  s_sub_u32 s68, s68, s66
  s_add_u32 s66, s94, s68
  s_lshl_b32 s66, s66, 10
  buffer_load_dwordx4 v[208:211], v246, s[40:43], s66 offen sc1
  buffer_load_dwordx4 v[212:215], v249, s[40:43], s66 offen sc1
  s_add_u32 s68, s91, 3
  s_cmp_ge_u32 s68, s92
  s_cselect_b32 s66, s92, 0
  s_sub_u32 s68, s68, s66
  s_add_u32 s66, s94, s68
  s_lshl_b32 s66, s66, 10
  buffer_load_dwordx4 v[216:219], v246, s[40:43], s66 offen sc1
  buffer_load_dwordx4 v[220:223], v249, s[40:43], s66 offen sc1
  s_add_u32 s68, s91, 4
  s_cmp_ge_u32 s68, s92
  s_cselect_b32 s66, s92, 0
  s_sub_u32 s68, s68, s66
  s_add_u32 s66, s94, s68
  s_lshl_b32 s66, s66, 10
  buffer_load_dwordx4 v[224:227], v246, s[40:43], s66 offen sc1
  buffer_load_dwordx4 v[228:231], v249, s[40:43], s66 offen sc1
  s_waitcnt vmcnt(8)
  v_mfma_f32_32x32x16_bf16 v[0:15], v[64:67], v[192:195], 0
  v_mfma_f32_32x32x16_bf16 v[16:31], v[68:71], v[192:195], 0
  v_mfma_f32_32x32x16_bf16 v[32:47], v[64:67], v[196:199], 0
  v_mfma_f32_32x32x16_bf16 v[48:63], v[68:71], v[196:199], 0
  s_add_u32 s68, s91, 5
  s_cmp_ge_u32 s68, s92
  s_cselect_b32 s66, s92, 0
  s_sub_u32 s68, s68, s66
  s_add_u32 s66, s94, s68
  s_lshl_b32 s66, s66, 10
  buffer_load_dwordx4 v[192:195], v246, s[40:43], s66 offen sc1
  buffer_load_dwordx4 v[196:199], v249, s[40:43], s66 offen sc1
  s_waitcnt vmcnt(8)
  v_mfma_f32_32x32x16_bf16 v[0:15], v[72:75], v[200:203], v[0:15]
  v_mfma_f32_32x32x16_bf16 v[16:31], v[76:79], v[200:203], v[16:31]
  v_mfma_f32_32x32x16_bf16 v[32:47], v[72:75], v[204:207], v[32:47]
  v_mfma_f32_32x32x16_bf16 v[48:63], v[76:79], v[204:207], v[48:63]
  s_add_u32 s68, s91, 6
  s_cmp_ge_u32 s68, s92
  s_cselect_b32 s66, s92, 0
  s_sub_u32 s68, s68, s66
L_WP_3:
  s_cbranch_execz L_WP_4
  s_add_u32 s66, s94, s68
  s_lshl_b32 s66, s66, 10
  buffer_load_dwordx4 v[200:203], v246, s[40:43], s66 offen sc1
  buffer_load_dwordx4 v[204:207], v249, s[40:43], s66 offen sc1
  s_waitcnt vmcnt(8)
  v_mfma_f32_32x32x16_bf16 v[0:15], v[80:83], v[208:211], v[0:15]
  v_mfma_f32_32x32x16_bf16 v[16:31], v[84:87], v[208:211], v[16:31]
  v_mfma_f32_32x32x16_bf16 v[32:47], v[80:83], v[212:215], v[32:47]
  v_mfma_f32_32x32x16_bf16 v[48:63], v[84:87], v[212:215], v[48:63]
  s_add_u32 s68, s91, 7
  s_cmp_ge_u32 s68, s92
  s_cselect_b32 s66, s92, 0
  s_sub_u32 s68, s68, s66
  s_add_u32 s66, s94, s68
  s_lshl_b32 s66, s66, 10
  buffer_load_dwordx4 v[208:211], v246, s[40:43], s66 offen sc1
  buffer_load_dwordx4 v[212:215], v249, s[40:43], s66 offen sc1
  s_waitcnt vmcnt(8)
  v_mfma_f32_32x32x16_bf16 v[0:15], v[88:91], v[216:219], v[0:15]
  v_mfma_f32_32x32x16_bf16 v[16:31], v[92:95], v[216:219], v[16:31]
  v_mfma_f32_32x32x16_bf16 v[32:47], v[88:91], v[220:223], v[32:47]
  v_mfma_f32_32x32x16_bf16 v[48:63], v[92:95], v[220:223], v[48:63]
  s_add_u32 s68, s91, 8
  s_cmp_ge_u32 s68, s92
  s_cselect_b32 s66, s92, 0
  s_sub_u32 s68, s68, s66
  s_add_u32 s66, s94, s68
  s_lshl_b32 s66, s66, 10
  buffer_load_dwordx4 v[216:219], v246, s[40:43], s66 offen sc1
  buffer_load_dwordx4 v[220:223], v249, s[40:43], s66 offen sc1
  s_waitcnt vmcnt(8)
  v_mfma_f32_32x32x16_bf16 v[0:15], v[96:99], v[224:227], v[0:15]
  v_mfma_f32_32x32x16_bf16 v[16:31], v[100:103], v[224:227], v[16:31]
  v_mfma_f32_32x32x16_bf16 v[32:47], v[96:99], v[228:231], v[32:47]
  v_mfma_f32_32x32x16_bf16 v[48:63], v[100:103], v[228:231], v[48:63]
  s_add_u32 s68, s91, 9
  s_cmp_ge_u32 s68, s92
  s_cselect_b32 s66, s92, 0
  s_sub_u32 s68, s68, s66
  s_add_u32 s66, s94, s68
  s_lshl_b32 s66, s66, 10
  buffer_load_dwordx4 v[224:227], v246, s[40:43], s66 offen sc1
  buffer_load_dwordx4 v[228:231], v249, s[40:43], s66 offen sc1
L_WP_4:
  s_cbranch_execz L_WP_5
  s_waitcnt vmcnt(8)
  v_mfma_f32_32x32x16_bf16 v[0:15], v[104:107], v[192:195], v[0:15]
  v_mfma_f32_32x32x16_bf16 v[16:31], v[108:111], v[192:195], v[16:31]
  v_mfma_f32_32x32x16_bf16 v[32:47], v[104:107], v[196:199], v[32:47]
  v_mfma_f32_32x32x16_bf16 v[48:63], v[108:111], v[196:199], v[48:63]
  s_add_u32 s68, s91, 10
  s_cmp_ge_u32 s68, s92
  s_cselect_b32 s66, s92, 0
  s_sub_u32 s68, s68, s66
  s_add_u32 s66, s94, s68
  s_lshl_b32 s66, s66, 10
  buffer_load_dwordx4 v[192:195], v246, s[40:43], s66 offen sc1
  buffer_load_dwordx4 v[196:199], v249, s[40:43], s66 offen sc1
  s_waitcnt vmcnt(8)
  v_mfma_f32_32x32x16_bf16 v[0:15], v[112:115], v[200:203], v[0:15]
  v_mfma_f32_32x32x16_bf16 v[16:31], v[116:119], v[200:203], v[16:31]
  v_mfma_f32_32x32x16_bf16 v[32:47], v[112:115], v[204:207], v[32:47]
  v_mfma_f32_32x32x16_bf16 v[48:63], v[116:119], v[204:207], v[48:63]
  s_add_u32 s68, s91, 11
  s_cmp_ge_u32 s68, s92
  s_cselect_b32 s66, s92, 0
  s_sub_u32 s68, s68, s66
  s_add_u32 s66, s94, s68
  s_lshl_b32 s66, s66, 10
  buffer_load_dwordx4 v[200:203], v246, s[40:43], s66 offen sc1
  buffer_load_dwordx4 v[204:207], v249, s[40:43], s66 offen sc1
  s_waitcnt vmcnt(8)
  v_mfma_f32_32x32x16_bf16 v[0:15], v[120:123], v[208:211], v[0:15]
  v_mfma_f32_32x32x16_bf16 v[16:31], v[124:127], v[208:211], v[16:31]
  v_mfma_f32_32x32x16_bf16 v[32:47], v[120:123], v[212:215], v[32:47]
  v_mfma_f32_32x32x16_bf16 v[48:63], v[124:127], v[212:215], v[48:63]
  s_add_u32 s68, s91, 12
  s_cmp_ge_u32 s68, s92
  s_cselect_b32 s66, s92, 0
  s_sub_u32 s68, s68, s66
  s_add_u32 s66, s94, s68
  s_lshl_b32 s66, s66, 10
  buffer_load_dwordx4 v[208:211], v246, s[40:43], s66 offen sc1
  buffer_load_dwordx4 v[212:215], v249, s[40:43], s66 offen sc1
  s_waitcnt vmcnt(8)
  v_mfma_f32_32x32x16_bf16 v[0:15], v[128:131], v[216:219], v[0:15]
  v_mfma_f32_32x32x16_bf16 v[16:31], v[132:135], v[216:219], v[16:31]
L_WP_5:
  s_cbranch_execz L_WP_6
  v_mfma_f32_32x32x16_bf16 v[32:47], v[128:131], v[220:223], v[32:47]
  v_mfma_f32_32x32x16_bf16 v[48:63], v[132:135], v[220:223], v[48:63]
  s_add_u32 s68, s91, 13
  s_cmp_ge_u32 s68, s92
  s_cselect_b32 s66, s92, 0
  s_sub_u32 s68, s68, s66
  s_add_u32 s66, s94, s68
  s_lshl_b32 s66, s66, 10
  s_cmp_gt_u32 s92, 13
  s_cselect_b32 s66, s66, 2130706432
  buffer_load_dwordx4 v[216:219], v246, s[40:43], s66 offen sc1
  buffer_load_dwordx4 v[220:223], v249, s[40:43], s66 offen sc1
  s_waitcnt vmcnt(8)
  v_mfma_f32_32x32x16_bf16 v[0:15], v[136:139], v[224:227], v[0:15]
  v_mfma_f32_32x32x16_bf16 v[16:31], v[140:143], v[224:227], v[16:31]
  v_mfma_f32_32x32x16_bf16 v[32:47], v[136:139], v[228:231], v[32:47]
  v_mfma_f32_32x32x16_bf16 v[48:63], v[140:143], v[228:231], v[48:63]
  buffer_load_dwordx4 v[250:253], v248, s[24:27], 0 offen
  s_waitcnt vmcnt(7)
  v_mfma_f32_32x32x16_bf16 v[0:15], v[144:147], v[192:195], v[0:15]
  v_mfma_f32_32x32x16_bf16 v[16:31], v[148:151], v[192:195], v[16:31]
  v_mfma_f32_32x32x16_bf16 v[32:47], v[144:147], v[196:199], v[32:47]
  v_mfma_f32_32x32x16_bf16 v[48:63], v[148:151], v[196:199], v[48:63]
  s_waitcnt vmcnt(5)
  v_mfma_f32_32x32x16_bf16 v[0:15], v[152:155], v[200:203], v[0:15]
  v_mfma_f32_32x32x16_bf16 v[16:31], v[156:159], v[200:203], v[16:31]
  v_mfma_f32_32x32x16_bf16 v[32:47], v[152:155], v[204:207], v[32:47]
  v_mfma_f32_32x32x16_bf16 v[48:63], v[156:159], v[204:207], v[48:63]
  s_waitcnt vmcnt(3)
  v_mfma_f32_32x32x16_bf16 v[0:15], v[160:163], v[208:211], v[0:15]
  v_mfma_f32_32x32x16_bf16 v[16:31], v[164:167], v[208:211], v[16:31]
  v_mfma_f32_32x32x16_bf16 v[32:47], v[160:163], v[212:215], v[32:47]
  v_mfma_f32_32x32x16_bf16 v[48:63], v[164:167], v[212:215], v[48:63]
  s_cmp_eq_u32 s92, 13
  s_cbranch_scc1 L_P2E
  s_waitcnt vmcnt(1)
  v_mfma_f32_32x32x16_bf16 v[0:15], v[168:171], v[216:219], v[0:15]
  v_mfma_f32_32x32x16_bf16 v[16:31], v[172:175], v[216:219], v[16:31]
  v_mfma_f32_32x32x16_bf16 v[32:47], v[168:171], v[220:223], v[32:47]
L_WP_6:
  s_cbranch_execz L_WP_7
  v_mfma_f32_32x32x16_bf16 v[48:63], v[172:175], v[220:223], v[48:63]
  s_branch L_P2E
L_P2C:
  s_add_u32 s68, s91, 0
  s_cmp_ge_u32 s68, s92
  s_cselect_b32 s66, s92, 0
  s_sub_u32 s68, s68, s66
  s_add_u32 s66, s94, s68
  s_lshl_b32 s66, s66, 10
  buffer_load_dwordx4 v[96:99], v246, s[40:43], s66 offen sc1
  buffer_load_dwordx4 v[100:103], v249, s[40:43], s66 offen sc1
  s_add_u32 s68, s91, 1
  s_cmp_ge_u32 s68, s92
  s_cselect_b32 s66, s92, 0
  s_sub_u32 s68, s68, s66
  s_add_u32 s66, s94, s68
  s_lshl_b32 s66, s66, 10
  buffer_load_dwordx4 v[104:107], v246, s[40:43], s66 offen sc1
  buffer_load_dwordx4 v[108:111], v249, s[40:43], s66 offen sc1
  s_add_u32 s68, s91, 2
  s_cmp_ge_u32 s68, s92
  s_cselect_b32 s66, s92, 0
  s_sub_u32 s68, s68, s66
  s_add_u32 s66, s94, s68
  s_lshl_b32 s66, s66, 10
  buffer_load_dwordx4 v[112:115], v246, s[40:43], s66 offen sc1
  buffer_load_dwordx4 v[116:119], v249, s[40:43], s66 offen sc1
  s_add_u32 s68, s91, 3
  s_cmp_ge_u32 s68, s92
  s_cselect_b32 s66, s92, 0
  s_sub_u32 s68, s68, s66
  s_add_u32 s66, s94, s68
  s_lshl_b32 s66, s66, 10
  buffer_load_dwordx4 v[120:123], v246, s[40:43], s66 offen sc1
  buffer_load_dwordx4 v[124:127], v249, s[40:43], s66 offen sc1
  s_add_u32 s68, s91, 4
  s_cmp_ge_u32 s68, s92
  s_cselect_b32 s66, s92, 0
  s_sub_u32 s68, s68, s66
  s_add_u32 s66, s94, s68
  s_lshl_b32 s66, s66, 10
  buffer_load_dwordx4 v[128:131], v246, s[40:43], s66 offen sc1
  buffer_load_dwordx4 v[132:135], v249, s[40:43], s66 offen sc1
  s_mov_b32 s70, 0
L_pw_78:
  ds_read_b32 v239, v238
  s_add_u32 s70, s70, 1
  s_waitcnt lgkmcnt(0)
  v_cmp_gt_u32 vcc, 11, v239
  s_cmp_lt_u32 s70, 0x400000
  s_cbranch_vccz L_pwd_79
L_WP_7:
  s_cbranch_execz L_WRET
  s_cbranch_scc1 L_pw_78
L_pwd_79:
  ds_read_b128 v[64:67], v241 offset:40960
  ds_read_b128 v[68:71], v241 offset:41984
  ds_read_b128 v[72:75], v241 offset:49152
  ds_read_b128 v[76:79], v241 offset:50176
  ds_read_b128 v[80:83], v241 offset:57344
  ds_read_b128 v[84:87], v241 offset:58368
  s_waitcnt vmcnt(8) lgkmcnt(4)
  v_mfma_f32_32x32x16_bf16 v[0:15], v[64:67], v[96:99], 0
  v_mfma_f32_32x32x16_bf16 v[16:31], v[68:71], v[96:99], 0
  v_mfma_f32_32x32x16_bf16 v[32:47], v[64:67], v[100:103], 0
  v_mfma_f32_32x32x16_bf16 v[48:63], v[68:71], v[100:103], 0
  s_add_u32 s68, s91, 5
  s_cmp_ge_u32 s68, s92
  s_cselect_b32 s66, s92, 0
  s_sub_u32 s68, s68, s66
  s_add_u32 s66, s94, s68
  s_lshl_b32 s66, s66, 10
  buffer_load_dwordx4 v[96:99], v246, s[40:43], s66 offen sc1
  buffer_load_dwordx4 v[100:103], v249, s[40:43], s66 offen sc1
  ds_read_b128 v[64:67], v242 offset:0
  ds_read_b128 v[68:71], v242 offset:1024
  s_waitcnt vmcnt(8) lgkmcnt(4)
  v_mfma_f32_32x32x16_bf16 v[0:15], v[72:75], v[104:107], v[0:15]
  v_mfma_f32_32x32x16_bf16 v[16:31], v[76:79], v[104:107], v[16:31]
  v_mfma_f32_32x32x16_bf16 v[32:47], v[72:75], v[108:111], v[32:47]
  v_mfma_f32_32x32x16_bf16 v[48:63], v[76:79], v[108:111], v[48:63]
  s_add_u32 s68, s91, 6
  s_cmp_ge_u32 s68, s92
  s_cselect_b32 s66, s92, 0
  s_sub_u32 s68, s68, s66
  s_add_u32 s66, s94, s68
  s_lshl_b32 s66, s66, 10
  buffer_load_dwordx4 v[104:107], v246, s[40:43], s66 offen sc1
  buffer_load_dwordx4 v[108:111], v249, s[40:43], s66 offen sc1
  ds_read_b128 v[72:75], v242 offset:8192
  ds_read_b128 v[76:79], v242 offset:9216
  s_waitcnt vmcnt(8) lgkmcnt(4)
  v_mfma_f32_32x32x16_bf16 v[0:15], v[80:83], v[112:115], v[0:15]
L_WP_8:
  s_cbranch_execz L_WP_9
  v_mfma_f32_32x32x16_bf16 v[16:31], v[84:87], v[112:115], v[16:31]
  v_mfma_f32_32x32x16_bf16 v[32:47], v[80:83], v[116:119], v[32:47]
  v_mfma_f32_32x32x16_bf16 v[48:63], v[84:87], v[116:119], v[48:63]
  s_add_u32 s68, s91, 7
  s_cmp_ge_u32 s68, s92
  s_cselect_b32 s66, s92, 0
  s_sub_u32 s68, s68, s66
  s_add_u32 s66, s94, s68
  s_lshl_b32 s66, s66, 10
  buffer_load_dwordx4 v[112:115], v246, s[40:43], s66 offen sc1
  buffer_load_dwordx4 v[116:119], v249, s[40:43], s66 offen sc1
  ds_read_b128 v[80:83], v242 offset:16384
  ds_read_b128 v[84:87], v242 offset:17408
  s_waitcnt vmcnt(8) lgkmcnt(4)
  v_mfma_f32_32x32x16_bf16 v[0:15], v[64:67], v[120:123], v[0:15]
  v_mfma_f32_32x32x16_bf16 v[16:31], v[68:71], v[120:123], v[16:31]
  v_mfma_f32_32x32x16_bf16 v[32:47], v[64:67], v[124:127], v[32:47]
  v_mfma_f32_32x32x16_bf16 v[48:63], v[68:71], v[124:127], v[48:63]
  s_add_u32 s68, s91, 8
  s_cmp_ge_u32 s68, s92
  s_cselect_b32 s66, s92, 0
  s_sub_u32 s68, s68, s66
  s_add_u32 s66, s94, s68
  s_lshl_b32 s66, s66, 10
  buffer_load_dwordx4 v[120:123], v246, s[40:43], s66 offen sc1
  buffer_load_dwordx4 v[124:127], v249, s[40:43], s66 offen sc1
  s_waitcnt vmcnt(8) lgkmcnt(2)
  v_mfma_f32_32x32x16_bf16 v[0:15], v[72:75], v[128:131], v[0:15]
  v_mfma_f32_32x32x16_bf16 v[16:31], v[76:79], v[128:131], v[16:31]
  v_mfma_f32_32x32x16_bf16 v[32:47], v[72:75], v[132:135], v[32:47]
  v_mfma_f32_32x32x16_bf16 v[48:63], v[76:79], v[132:135], v[48:63]
  s_add_u32 s68, s91, 9
  s_cmp_ge_u32 s68, s92
  s_cselect_b32 s66, s92, 0
  s_sub_u32 s68, s68, s66
  s_add_u32 s66, s94, s68
  s_lshl_b32 s66, s66, 10
  buffer_load_dwordx4 v[128:131], v246, s[40:43], s66 offen sc1
  buffer_load_dwordx4 v[132:135], v249, s[40:43], s66 offen sc1
  s_waitcnt vmcnt(8) lgkmcnt(0)
  v_mfma_f32_32x32x16_bf16 v[0:15], v[80:83], v[96:99], v[0:15]
  v_mfma_f32_32x32x16_bf16 v[16:31], v[84:87], v[96:99], v[16:31]
L_WP_9:
  s_cbranch_execz L_WP_10
  v_mfma_f32_32x32x16_bf16 v[32:47], v[80:83], v[100:103], v[32:47]
  v_mfma_f32_32x32x16_bf16 v[48:63], v[84:87], v[100:103], v[48:63]
  s_add_u32 s68, s91, 10
  s_cmp_ge_u32 s68, s92
  s_cselect_b32 s66, s92, 0
  s_sub_u32 s68, s68, s66
  s_add_u32 s66, s94, s68
  s_lshl_b32 s66, s66, 10
  buffer_load_dwordx4 v[96:99], v246, s[40:43], s66 offen sc1
  buffer_load_dwordx4 v[100:103], v249, s[40:43], s66 offen sc1
  s_waitcnt vmcnt(8)
  v_mfma_f32_32x32x16_bf16 v[0:15], v[192:195], v[104:107], v[0:15]
  v_mfma_f32_32x32x16_bf16 v[16:31], v[196:199], v[104:107], v[16:31]
  v_mfma_f32_32x32x16_bf16 v[32:47], v[192:195], v[108:111], v[32:47]
  v_mfma_f32_32x32x16_bf16 v[48:63], v[196:199], v[108:111], v[48:63]
  s_add_u32 s68, s91, 11
  s_cmp_ge_u32 s68, s92
  s_cselect_b32 s66, s92, 0
  s_sub_u32 s68, s68, s66
  s_add_u32 s66, s94, s68
  s_lshl_b32 s66, s66, 10
  buffer_load_dwordx4 v[104:107], v246, s[40:43], s66 offen sc1
  buffer_load_dwordx4 v[108:111], v249, s[40:43], s66 offen sc1
  s_waitcnt vmcnt(8)
  v_mfma_f32_32x32x16_bf16 v[0:15], v[200:203], v[112:115], v[0:15]
  v_mfma_f32_32x32x16_bf16 v[16:31], v[204:207], v[112:115], v[16:31]
  v_mfma_f32_32x32x16_bf16 v[32:47], v[200:203], v[116:119], v[32:47]
  v_mfma_f32_32x32x16_bf16 v[48:63], v[204:207], v[116:119], v[48:63]
  s_add_u32 s68, s91, 12
  s_cmp_ge_u32 s68, s92
  s_cselect_b32 s66, s92, 0
  s_sub_u32 s68, s68, s66
  s_add_u32 s66, s94, s68
  s_lshl_b32 s66, s66, 10
  buffer_load_dwordx4 v[112:115], v246, s[40:43], s66 offen sc1
  buffer_load_dwordx4 v[116:119], v249, s[40:43], s66 offen sc1
  ds_read_b128 v[72:75], v240 offset:24576
  ds_read_b128 v[76:79], v240 offset:25600
  s_waitcnt vmcnt(8)
  v_mfma_f32_32x32x16_bf16 v[0:15], v[208:211], v[120:123], v[0:15]
  v_mfma_f32_32x32x16_bf16 v[16:31], v[212:215], v[120:123], v[16:31]
  v_mfma_f32_32x32x16_bf16 v[32:47], v[208:211], v[124:127], v[32:47]
L_WP_10:
  s_cbranch_execz L_WP_11
  v_mfma_f32_32x32x16_bf16 v[48:63], v[212:215], v[124:127], v[48:63]
  s_add_u32 s68, s91, 13
  s_cmp_ge_u32 s68, s92
  s_cselect_b32 s66, s92, 0
  s_sub_u32 s68, s68, s66
  s_add_u32 s66, s94, s68
  s_lshl_b32 s66, s66, 10
  s_cmp_gt_u32 s92, 13
  s_cselect_b32 s66, s66, 2130706432
  buffer_load_dwordx4 v[120:123], v246, s[40:43], s66 offen sc1
  buffer_load_dwordx4 v[124:127], v249, s[40:43], s66 offen sc1
  ds_read_b128 v[80:83], v240 offset:32768
  ds_read_b128 v[84:87], v240 offset:33792
  s_waitcnt vmcnt(8)
  v_mfma_f32_32x32x16_bf16 v[0:15], v[216:219], v[128:131], v[0:15]
  v_mfma_f32_32x32x16_bf16 v[16:31], v[220:223], v[128:131], v[16:31]
  v_mfma_f32_32x32x16_bf16 v[32:47], v[216:219], v[132:135], v[32:47]
  v_mfma_f32_32x32x16_bf16 v[48:63], v[220:223], v[132:135], v[48:63]
  s_add_u32 s68, s91, 14
  s_cmp_ge_u32 s68, s92
  s_cselect_b32 s66, s92, 0
  s_sub_u32 s68, s68, s66
  s_add_u32 s66, s94, s68
  s_lshl_b32 s66, s66, 10
  s_cmp_gt_u32 s92, 14
  s_cselect_b32 s66, s66, 2130706432
  buffer_load_dwordx4 v[128:131], v246, s[40:43], s66 offen sc1
  buffer_load_dwordx4 v[132:135], v249, s[40:43], s66 offen sc1
  buffer_load_dwordx4 v[250:253], v248, s[24:27], 0 offen
  ds_read_b128 v[64:67], v240 offset:40960
  ds_read_b128 v[68:71], v240 offset:41984
  s_waitcnt vmcnt(9) lgkmcnt(4)
  v_mfma_f32_32x32x16_bf16 v[0:15], v[72:75], v[96:99], v[0:15]
  v_mfma_f32_32x32x16_bf16 v[16:31], v[76:79], v[96:99], v[16:31]
  v_mfma_f32_32x32x16_bf16 v[32:47], v[72:75], v[100:103], v[32:47]
  v_mfma_f32_32x32x16_bf16 v[48:63], v[76:79], v[100:103], v[48:63]
  s_add_u32 s68, s91, 15
  s_cmp_ge_u32 s68, s92
  s_cselect_b32 s66, s92, 0
  s_sub_u32 s68, s68, s66
  s_add_u32 s66, s94, s68
  s_lshl_b32 s66, s66, 10
  s_cmp_gt_u32 s92, 15
  s_cselect_b32 s66, s66, 2130706432
L_WP_11:
  s_cbranch_execz L_WP_12
  buffer_load_dwordx4 v[96:99], v246, s[40:43], s66 offen sc1
  buffer_load_dwordx4 v[100:103], v249, s[40:43], s66 offen sc1
  ds_read_b128 v[72:75], v240 offset:0
  ds_read_b128 v[76:79], v240 offset:1024
  s_waitcnt vmcnt(9) lgkmcnt(4)
  v_mfma_f32_32x32x16_bf16 v[0:15], v[80:83], v[104:107], v[0:15]
  v_mfma_f32_32x32x16_bf16 v[16:31], v[84:87], v[104:107], v[16:31]
  v_mfma_f32_32x32x16_bf16 v[32:47], v[80:83], v[108:111], v[32:47]
  v_mfma_f32_32x32x16_bf16 v[48:63], v[84:87], v[108:111], v[48:63]
  ds_read_b128 v[80:83], v240 offset:8192
  ds_read_b128 v[84:87], v240 offset:9216
  s_waitcnt vmcnt(7) lgkmcnt(4)
  v_mov_b32 v239, 10
  ds_write_b32 v238, v239 offset:16
  v_mfma_f32_32x32x16_bf16 v[0:15], v[64:67], v[112:115], v[0:15]
  v_mfma_f32_32x32x16_bf16 v[16:31], v[68:71], v[112:115], v[16:31]
  v_mfma_f32_32x32x16_bf16 v[32:47], v[64:67], v[116:119], v[32:47]
  v_mfma_f32_32x32x16_bf16 v[48:63], v[68:71], v[116:119], v[48:63]
  ds_read_b128 v[64:67], v240 offset:16384
  ds_read_b128 v[68:71], v240 offset:17408
  s_waitcnt vmcnt(5) lgkmcnt(5)
  v_mfma_f32_32x32x16_bf16 v[0:15], v[72:75], v[120:123], v[0:15]
  v_mfma_f32_32x32x16_bf16 v[16:31], v[76:79], v[120:123], v[16:31]
  v_mfma_f32_32x32x16_bf16 v[32:47], v[72:75], v[124:127], v[32:47]
  v_mfma_f32_32x32x16_bf16 v[48:63], v[76:79], v[124:127], v[48:63]
  s_waitcnt vmcnt(3) lgkmcnt(3)
  v_mfma_f32_32x32x16_bf16 v[0:15], v[80:83], v[128:131], v[0:15]
  v_mfma_f32_32x32x16_bf16 v[16:31], v[84:87], v[128:131], v[16:31]
  v_mfma_f32_32x32x16_bf16 v[32:47], v[80:83], v[132:135], v[32:47]
  v_mfma_f32_32x32x16_bf16 v[48:63], v[84:87], v[132:135], v[48:63]
  s_waitcnt vmcnt(0) lgkmcnt(0)
  v_mfma_f32_32x32x16_bf16 v[0:15], v[64:67], v[96:99], v[0:15]
  v_mfma_f32_32x32x16_bf16 v[16:31], v[68:71], v[96:99], v[16:31]
  v_mfma_f32_32x32x16_bf16 v[32:47], v[64:67], v[100:103], v[32:47]
L_WP_12:
  s_cbranch_execz L_WP_13
  v_mfma_f32_32x32x16_bf16 v[48:63], v[68:71], v[100:103], v[48:63]
L_P2E:
  s_mov_b32 s70, 0
L_sp_80:
  ds_read_b128 v[64:67], v236 offset:16
  s_add_u32 s70, s70, 1
  s_waitcnt lgkmcnt(0)
  v_min_u32 v64, v64, v65
  v_min3_u32 v64, v64, v66, v67
  v_cmp_gt_u32 vcc, 10, v64
  s_cmp_lt_u32 s70, 0x400000
  s_cbranch_vccz L_spd_81
  s_sleep 0
  s_cbranch_scc1 L_sp_80
L_spd_81:
  ds_write_b128 v232, v[0:3] offset:0
  ds_write_b128 v233, v[4:7] offset:0
  ds_write_b128 v234, v[8:11] offset:0
  ds_write_b128 v235, v[12:15] offset:0
  ds_write_b128 v232, v[16:19] offset:128
  ds_write_b128 v233, v[20:23] offset:128
  ds_write_b128 v234, v[24:27] offset:128
  ds_write_b128 v235, v[28:31] offset:128
  ds_write_b128 v232, v[32:35] offset:8192
  ds_write_b128 v233, v[36:39] offset:8192
  ds_write_b128 v234, v[40:43] offset:8192
  ds_write_b128 v235, v[44:47] offset:8192
  ds_write_b128 v232, v[48:51] offset:8320
  ds_write_b128 v233, v[52:55] offset:8320
  ds_write_b128 v234, v[56:59] offset:8320
  ds_write_b128 v235, v[60:63] offset:8320
  s_mov_b32 s66, 0xbfb8aa3b
  s_mov_b32 s67, 0xbfb8aa3b
  s_mov_b32 s68, 1.0
  s_mov_b32 s69, 1.0
  s_waitcnt vmcnt(0)
  v_lshlrev_b32 v140, 16, v250
  v_and_b32 v141, 0xffff0000, v250
  v_lshlrev_b32 v142, 16, v251
  v_and_b32 v143, 0xffff0000, v251
  v_lshlrev_b32 v144, 16, v252
  v_and_b32 v145, 0xffff0000, v252
  v_lshlrev_b32 v146, 16, v253
  v_and_b32 v147, 0xffff0000, v253
L_WP_13:
  s_cbranch_execz L_WP_14
  s_waitcnt lgkmcnt(0)
  s_barrier
  ds_read_b128 v[88:91], v243 offset:32768
  ds_read_b128 v[92:95], v244 offset:32768
  ds_read_b128 v[96:99], v243 offset:49152
  ds_read_b128 v[100:103], v244 offset:49152
  ds_read_b128 v[104:107], v245 offset:0
  ds_read_b128 v[108:111], v247 offset:0
  ds_read_b128 v[112:115], v245 offset:16384
  ds_read_b128 v[116:119], v247 offset:16384
  ds_read_b128 v[120:123], v245 offset:32768
  ds_read_b128 v[124:127], v247 offset:32768
  ds_read_b128 v[128:131], v245 offset:49152
  ds_read_b128 v[132:135], v247 offset:49152
  ds_read_b128 v[72:75], v243 offset:0
  ds_read_b128 v[76:79], v244 offset:0
  ds_read_b128 v[80:83], v243 offset:16384
  ds_read_b128 v[84:87], v244 offset:16384
  s_waitcnt lgkmcnt(12)
  v_pk_add_f32 v[88:89], v[88:89], v[96:97]
  v_pk_add_f32 v[90:91], v[90:91], v[98:99]
  v_pk_add_f32 v[92:93], v[92:93], v[100:101]
  v_pk_add_f32 v[94:95], v[94:95], v[102:103]
  s_waitcnt lgkmcnt(10)
  v_pk_add_f32 v[88:89], v[88:89], v[104:105]
  v_pk_add_f32 v[90:91], v[90:91], v[106:107]
  v_pk_add_f32 v[92:93], v[92:93], v[108:109]
  v_pk_add_f32 v[94:95], v[94:95], v[110:111]
  s_waitcnt lgkmcnt(8)
  v_pk_add_f32 v[88:89], v[88:89], v[112:113]
  v_pk_add_f32 v[90:91], v[90:91], v[114:115]
  v_pk_add_f32 v[92:93], v[92:93], v[116:117]
  v_pk_add_f32 v[94:95], v[94:95], v[118:119]
  s_waitcnt lgkmcnt(6)
L_WP_14:
  s_cbranch_execz L_WP_15
  v_pk_add_f32 v[88:89], v[88:89], v[120:121]
  v_pk_add_f32 v[90:91], v[90:91], v[122:123]
  v_pk_add_f32 v[92:93], v[92:93], v[124:125]
  v_pk_add_f32 v[94:95], v[94:95], v[126:127]
  s_waitcnt lgkmcnt(4)
  v_pk_add_f32 v[88:89], v[88:89], v[128:129]
  v_pk_add_f32 v[90:91], v[90:91], v[130:131]
  v_pk_add_f32 v[92:93], v[92:93], v[132:133]
  v_pk_add_f32 v[94:95], v[94:95], v[134:135]
  v_pk_mul_f32 v[148:149], v[88:89], s[66:67]
  v_pk_mul_f32 v[150:151], v[90:91], s[66:67]
  v_pk_mul_f32 v[152:153], v[92:93], s[66:67]
  v_pk_mul_f32 v[154:155], v[94:95], s[66:67]
  s_waitcnt lgkmcnt(0)
  v_exp_f32 v148, v148
  v_exp_f32 v149, v149
  v_pk_add_f32 v[72:73], v[72:73], v[80:81]
  v_exp_f32 v150, v150
  v_exp_f32 v151, v151
  v_pk_add_f32 v[74:75], v[74:75], v[82:83]
  v_exp_f32 v152, v152
  v_exp_f32 v153, v153
  v_pk_add_f32 v[76:77], v[76:77], v[84:85]
  v_exp_f32 v154, v154
  v_exp_f32 v155, v155
  v_pk_add_f32 v[78:79], v[78:79], v[86:87]
  v_pk_add_f32 v[148:149], v[148:149], s[68:69]
  v_pk_add_f32 v[150:151], v[150:151], s[68:69]
  v_pk_add_f32 v[152:153], v[152:153], s[68:69]
  v_pk_add_f32 v[154:155], v[154:155], s[68:69]
  v_rcp_f32 v148, v148
  v_rcp_f32 v149, v149
  v_pk_mul_f32 v[88:89], v[88:89], v[72:73]
  v_rcp_f32 v150, v150
  v_rcp_f32 v151, v151
  v_pk_mul_f32 v[90:91], v[90:91], v[74:75]
  v_rcp_f32 v152, v152
  v_rcp_f32 v153, v153
  v_pk_mul_f32 v[92:93], v[92:93], v[76:77]
L_WP_15:
  s_cbranch_execz L_WRET
  v_rcp_f32 v154, v154
  v_rcp_f32 v155, v155
  v_pk_mul_f32 v[94:95], v[94:95], v[78:79]
  v_pk_fma_f32 v[88:89], v[88:89], v[148:149], v[140:141]
  v_pk_fma_f32 v[90:91], v[90:91], v[150:151], v[142:143]
  v_pk_fma_f32 v[92:93], v[92:93], v[152:153], v[144:145]
  v_pk_fma_f32 v[94:95], v[94:95], v[154:155], v[146:147]
  v_cvt_pk_bf16_f32 v156, v88, v89
  v_cvt_pk_bf16_f32 v157, v90, v91
  v_cvt_pk_bf16_f32 v158, v92, v93
  v_cvt_pk_bf16_f32 v159, v94, v95
  buffer_store_dwordx4 v[156:159], v248, s[52:55], 0 offen sc1
L_END:
  s_endpgm
L_C:
  s_waitcnt lgkmcnt(0)
  s_mov_b32 s36, s22
  s_mov_b32 s37, s23
  s_mov_b32 s38, 16777216
  s_mov_b32 s39, 0x20000
  s_mov_b32 s40, s22
  s_mov_b32 s41, s23
  s_mov_b32 s42, 7733248
  s_mov_b32 s43, 0x20000
  s_mov_b32 s52, s18
  s_mov_b32 s53, s19
  s_mov_b32 s54, 2097152
  s_mov_b32 s55, 0x20000
  s_lshl_b32 s68, s56, 3
  s_mov_b32 s66, 807407616
  s_mov_b32 s67, 1750748480
  s_lshr_b64 s[66:67], s[66:67], s68
  s_and_b32 s94, s66, 0xff
  s_mov_b32 s66, 269488144
  s_mov_b32 s67, 235801869
  s_lshr_b64 s[66:67], s[66:67], s68
  s_and_b32 s92, s66, 0xff
  s_lshl_b32 s69, s62, 7
  s_add_u32 s69, s69, 5120
  s_add_u32 s93, s94, s69
  s_lshl_b32 s95, s60, 11
  s_mul_i32 s91, s62, 2
  s_mul_i32 s66, s61, 4
  s_add_u32 s91, s91, s66
  s_and_b32 s91, s91, 15
  s_cmp_ge_u32 s91, s92
  s_cselect_b32 s66, s92, 0
  s_sub_u32 s91, s91, s66
  s_mul_i32 s66, s61, 236
  s_add_u32 s94, s94, s66
  v_mov_b32 v0, 0
  v_mov_b32 v1, 0
  v_mov_b32 v2, 0
  v_mov_b32 v3, 0
  v_mov_b32 v4, 0
  v_mov_b32 v5, 0
  v_mov_b32 v6, 0
  v_mov_b32 v7, 0
  v_mov_b32 v8, 0
  v_mov_b32 v9, 0
  v_mov_b32 v10, 0
  v_mov_b32 v11, 0
  v_mov_b32 v12, 0
  v_mov_b32 v13, 0
  v_mov_b32 v14, 0
  v_mov_b32 v15, 0
  v_mov_b32 v16, 0
  v_mov_b32 v17, 0
  v_mov_b32 v18, 0
  v_mov_b32 v19, 0
  v_mov_b32 v20, 0
  v_mov_b32 v21, 0
  v_mov_b32 v22, 0
  v_mov_b32 v23, 0
  v_mov_b32 v24, 0
  v_mov_b32 v25, 0
  v_mov_b32 v26, 0
  v_mov_b32 v27, 0
  v_mov_b32 v28, 0
  v_mov_b32 v29, 0
  v_mov_b32 v30, 0
  v_mov_b32 v31, 0
  v_mov_b32 v32, 0
  v_mov_b32 v33, 0
  v_mov_b32 v34, 0
  v_mov_b32 v35, 0
  v_mov_b32 v36, 0
  v_mov_b32 v37, 0
  v_mov_b32 v38, 0
  v_mov_b32 v39, 0
  v_mov_b32 v40, 0
  v_mov_b32 v41, 0
  v_mov_b32 v42, 0
  v_mov_b32 v43, 0
  v_mov_b32 v44, 0
  v_mov_b32 v45, 0
  v_mov_b32 v46, 0
  v_mov_b32 v47, 0
  v_mov_b32 v48, 0
  v_mov_b32 v49, 0
  v_mov_b32 v50, 0
  v_mov_b32 v51, 0
  v_mov_b32 v52, 0
  v_mov_b32 v53, 0
  v_mov_b32 v54, 0
  v_mov_b32 v55, 0
  v_mov_b32 v56, 0
  v_mov_b32 v57, 0
  v_mov_b32 v58, 0
  v_mov_b32 v59, 0
  v_mov_b32 v60, 0
  v_mov_b32 v61, 0
  v_mov_b32 v62, 0
  v_mov_b32 v63, 0
  v_mov_b32 v64, 0
  v_mov_b32 v65, 0
  v_mov_b32 v66, 0
  v_mov_b32 v67, 0
  v_mov_b32 v68, 0
  v_mov_b32 v69, 0
  v_mov_b32 v70, 0
  v_mov_b32 v71, 0
  v_mov_b32 v72, 0
  v_mov_b32 v73, 0
  v_mov_b32 v74, 0
  v_mov_b32 v75, 0
  v_mov_b32 v76, 0
  v_mov_b32 v77, 0
  v_mov_b32 v78, 0
  v_mov_b32 v79, 0
  v_mov_b32 v80, 0
  v_mov_b32 v81, 0
  v_mov_b32 v82, 0
  v_mov_b32 v83, 0
  v_mov_b32 v84, 0
  v_mov_b32 v85, 0
  v_mov_b32 v86, 0
  v_mov_b32 v87, 0
  v_mov_b32 v88, 0
  v_mov_b32 v89, 0
  v_mov_b32 v90, 0
  v_mov_b32 v91, 0
  v_mov_b32 v92, 0
  v_mov_b32 v93, 0
  v_mov_b32 v94, 0
  v_mov_b32 v95, 0
  v_mov_b32 v96, 0
  v_mov_b32 v97, 0
  v_mov_b32 v98, 0
  v_mov_b32 v99, 0
  v_mov_b32 v100, 0
  v_mov_b32 v101, 0
  v_mov_b32 v102, 0
  v_mov_b32 v103, 0
  v_mov_b32 v104, 0
  v_mov_b32 v105, 0
  v_mov_b32 v106, 0
  v_mov_b32 v107, 0
  v_mov_b32 v108, 0
  v_mov_b32 v109, 0
  v_mov_b32 v110, 0
  v_mov_b32 v111, 0
  v_mov_b32 v112, 0
  v_mov_b32 v113, 0
  v_mov_b32 v114, 0
  v_mov_b32 v115, 0
  v_mov_b32 v116, 0
  v_mov_b32 v117, 0
  v_mov_b32 v118, 0
  v_mov_b32 v119, 0
  v_mov_b32 v120, 0
  v_mov_b32 v121, 0
  v_mov_b32 v122, 0
  v_mov_b32 v123, 0
  v_mov_b32 v124, 0
  v_mov_b32 v125, 0
  v_mov_b32 v126, 0
  v_mov_b32 v127, 0
  v_mov_b32 v128, 0
  v_mov_b32 v129, 0
  v_mov_b32 v130, 0
  v_mov_b32 v131, 0
  v_mov_b32 v132, 0
  v_mov_b32 v133, 0
  v_mov_b32 v134, 0
  v_mov_b32 v135, 0
  v_mov_b32 v136, 0
  v_mov_b32 v137, 0
  v_mov_b32 v138, 0
  v_mov_b32 v139, 0
  v_mov_b32 v140, 0
  v_mov_b32 v141, 0
  v_mov_b32 v142, 0
  v_mov_b32 v143, 0
  v_mov_b32 v144, 0
  v_mov_b32 v145, 0
  v_mov_b32 v146, 0
  v_mov_b32 v147, 0
  v_mov_b32 v148, 0
  v_mov_b32 v149, 0
  v_mov_b32 v150, 0
  v_mov_b32 v151, 0
  s_mov_b32 s66, 0x3f803f80
  s_waitcnt vmcnt(0)
  v_dot2_f32_bf16 v212, v200, s66, 0
  v_dot2_f32_bf16 v213, v200, v200, 0
  v_dot2_f32_bf16 v214, v204, s66, 0
  v_dot2_f32_bf16 v215, v204, v204, 0
  v_dot2_f32_bf16 v216, v208, s66, 0
  v_dot2_f32_bf16 v217, v208, v208, 0
  v_dot2_f32_bf16 v212, v201, s66, v212
  v_dot2_f32_bf16 v213, v201, v201, v213
  v_dot2_f32_bf16 v214, v205, s66, v214
  v_dot2_f32_bf16 v215, v205, v205, v215
  v_dot2_f32_bf16 v216, v209, s66, v216
  v_dot2_f32_bf16 v217, v209, v209, v217
  v_dot2_f32_bf16 v212, v202, s66, v212
  v_dot2_f32_bf16 v213, v202, v202, v213
  v_dot2_f32_bf16 v214, v206, s66, v214
  v_dot2_f32_bf16 v215, v206, v206, v215
  v_dot2_f32_bf16 v216, v210, s66, v216
  v_dot2_f32_bf16 v217, v210, v210, v217
  v_dot2_f32_bf16 v212, v203, s66, v212
  v_dot2_f32_bf16 v213, v203, v203, v213
  v_dot2_f32_bf16 v214, v207, s66, v214
  v_dot2_f32_bf16 v215, v207, v207, v215
  v_dot2_f32_bf16 v216, v211, s66, v216
  v_dot2_f32_bf16 v217, v211, v211, v217
  s_nop 2
  v_add_f32_dpp v212, v212, v212 row_shr:1 row_mask:0xf bank_mask:0xf bound_ctrl:0
  v_add_f32_dpp v213, v213, v213 row_shr:1 row_mask:0xf bank_mask:0xf bound_ctrl:0
  v_add_f32_dpp v214, v214, v214 row_shr:1 row_mask:0xf bank_mask:0xf bound_ctrl:0
  v_add_f32_dpp v215, v215, v215 row_shr:1 row_mask:0xf bank_mask:0xf bound_ctrl:0
  v_add_f32_dpp v216, v216, v216 row_shr:1 row_mask:0xf bank_mask:0xf bound_ctrl:0
  v_add_f32_dpp v217, v217, v217 row_shr:1 row_mask:0xf bank_mask:0xf bound_ctrl:0
  v_add_f32_dpp v212, v212, v212 row_shr:2 row_mask:0xf bank_mask:0xf bound_ctrl:0
  v_add_f32_dpp v213, v213, v213 row_shr:2 row_mask:0xf bank_mask:0xf bound_ctrl:0
  v_add_f32_dpp v214, v214, v214 row_shr:2 row_mask:0xf bank_mask:0xf bound_ctrl:0
  v_add_f32_dpp v215, v215, v215 row_shr:2 row_mask:0xf bank_mask:0xf bound_ctrl:0
  v_add_f32_dpp v216, v216, v216 row_shr:2 row_mask:0xf bank_mask:0xf bound_ctrl:0
  v_add_f32_dpp v217, v217, v217 row_shr:2 row_mask:0xf bank_mask:0xf bound_ctrl:0
  v_add_f32_dpp v212, v212, v212 row_shr:4 row_mask:0xf bank_mask:0xf bound_ctrl:0
  v_add_f32_dpp v213, v213, v213 row_shr:4 row_mask:0xf bank_mask:0xf bound_ctrl:0
  v_add_f32_dpp v214, v214, v214 row_shr:4 row_mask:0xf bank_mask:0xf bound_ctrl:0
  v_add_f32_dpp v215, v215, v215 row_shr:4 row_mask:0xf bank_mask:0xf bound_ctrl:0
  v_add_f32_dpp v216, v216, v216 row_shr:4 row_mask:0xf bank_mask:0xf bound_ctrl:0
  v_add_f32_dpp v217, v217, v217 row_shr:4 row_mask:0xf bank_mask:0xf bound_ctrl:0
  v_add_f32_dpp v212, v212, v212 row_shr:8 row_mask:0xf bank_mask:0xf bound_ctrl:0
  v_add_f32_dpp v213, v213, v213 row_shr:8 row_mask:0xf bank_mask:0xf bound_ctrl:0
  v_add_f32_dpp v214, v214, v214 row_shr:8 row_mask:0xf bank_mask:0xf bound_ctrl:0
  v_add_f32_dpp v215, v215, v215 row_shr:8 row_mask:0xf bank_mask:0xf bound_ctrl:0
  v_add_f32_dpp v216, v216, v216 row_shr:8 row_mask:0xf bank_mask:0xf bound_ctrl:0
  v_add_f32_dpp v217, v217, v217 row_shr:8 row_mask:0xf bank_mask:0xf bound_ctrl:0
  v_add_f32_dpp v212, v212, v212 row_bcast:15 row_mask:0xa bank_mask:0xf
  v_add_f32_dpp v213, v213, v213 row_bcast:15 row_mask:0xa bank_mask:0xf
  v_add_f32_dpp v214, v214, v214 row_bcast:15 row_mask:0xa bank_mask:0xf
  v_add_f32_dpp v215, v215, v215 row_bcast:15 row_mask:0xa bank_mask:0xf
  v_add_f32_dpp v216, v216, v216 row_bcast:15 row_mask:0xa bank_mask:0xf
  v_add_f32_dpp v217, v217, v217 row_bcast:15 row_mask:0xa bank_mask:0xf
  v_add_f32_dpp v212, v212, v212 row_bcast:31 row_mask:0xc bank_mask:0xf
  v_add_f32_dpp v213, v213, v213 row_bcast:31 row_mask:0xc bank_mask:0xf
  v_add_f32_dpp v214, v214, v214 row_bcast:31 row_mask:0xc bank_mask:0xf
  v_add_f32_dpp v215, v215, v215 row_bcast:31 row_mask:0xc bank_mask:0xf
  v_add_f32_dpp v216, v216, v216 row_bcast:31 row_mask:0xc bank_mask:0xf
  v_add_f32_dpp v217, v217, v217 row_bcast:31 row_mask:0xc bank_mask:0xf
  s_mul_i32 s66, s56, 24
  s_add_u32 s66, s66, 158976
  v_mov_b32 v218, s66
  s_mov_b32 exec_lo, 0
  s_mov_b32 exec_hi, 0x80000000
  s_mov_b32 s67, 0x3b000000
  s_mov_b32 s68, 0x3727c5ac
  v_mul_f32 v212, s67, v212
  v_mul_f32 v213, s67, v213
  v_fma_f32 v213, -v212, v212, v213
  v_max_f32 v213, 0, v213
  v_add_f32 v213, s68, v213
  ds_write_b64 v218, v[212:213] offset:0
  v_mul_f32 v214, s67, v214
  v_mul_f32 v215, s67, v215
  v_fma_f32 v215, -v214, v214, v215
  v_max_f32 v215, 0, v215
  v_add_f32 v215, s68, v215
  ds_write_b64 v218, v[214:215] offset:8
  v_mul_f32 v216, s67, v216
  v_mul_f32 v217, s67, v217
  v_fma_f32 v217, -v216, v216, v217
  v_max_f32 v217, 0, v217
  v_add_f32 v217, s68, v217
  ds_write_b64 v218, v[216:217] offset:16
  s_mov_b64 exec, -1
  s_mul_i32 s74, s57, 23
  s_add_u32 s74, s74, s58
  s_lshl_b32 s74, s74, 7
  s_lshl_b32 s75, s56, 4
  s_add_u32 s74, s74, s75
  s_add_u32 s74, s74, 9175040
  s_mov_b64 exec, 0
  s_cmp_eq_u32 s56, 2
  s_cbranch_scc1 L_WP_0
  s_cmp_eq_u32 s56, 3
  s_cbranch_scc1 L_WP_8
  s_lshl_b32 s66, s59, 1
  s_add_u32 s66, s66, s56
  s_cmp_eq_u32 s66, 0
  s_cbranch_scc1 L_WF_0
  s_cmp_eq_u32 s66, 1
  s_cbranch_scc1 L_WF_7
  s_cmp_eq_u32 s66, 2
  s_cbranch_scc1 L_WQ_0
  s_branch L_WQ_10
L_WRET:
  s_mov_b64 exec, -1
  v_mov_b32 v246, 159696
  s_lshl_b32 s66, s56, 2
  v_add_u32 v245, s66, v246
  s_cmp_eq_u32 s59, 1
  s_cbranch_scc1 L_CQ
  s_lshr_b32 s66, s56, 1
  s_and_b32 s67, s56, 1
  s_mul_i32 s68, s66, 12288
  v_and_b32 v150, 15, v254
  v_bfe_u32 v151, v254, 1, 3
  v_lshrrev_b32 v152, 4, v254
  v_xor_b32 v151, v151, v152
  v_lshlrev_b32 v150, 7, v150
  v_add_u32 v150, s68, v150
  v_lshl_add_u32 v240, v151, 4, v150
  v_xor_b32 v241, 64, v240
  v_bfe_u32 v150, v254, 2, 2
  v_lshl_add_u32 v150, v152, 3, v150
  v_mul_u32_u24 v150, 192, v150
  v_and_b32 v151, 3, v254
  v_lshl_add_u32 v150, v151, 3, v150
  v_add_u32 v150, 24576, v150
  v_and_b32 v152, 1, v152
  s_mul_i32 s68, s67, 3
  s_add_u32 s69, s68, 0
  v_xor_b32 v151, s69, v152
  v_lshl_add_u32 v242, v151, 5, v150
  s_add_u32 s69, s68, 1
  v_xor_b32 v151, s69, v152
  v_lshl_add_u32 v243, v151, 5, v150
  s_add_u32 s69, s68, 2
  v_xor_b32 v151, s69, v152
  v_lshl_add_u32 v244, v151, 5, v150
  s_mov_b32 s78, 0
  s_mul_i32 s72, s57, 6
  s_mul_i32 s68, s66, 3
  s_add_u32 s72, s72, s68
  s_mul_i32 s72, s72, 118
  s_lshl_b32 s68, s58, 1
  s_add_u32 s68, s68, s67
  s_mul_i32 s71, s68, 3
  s_add_u32 s72, s72, s71
  s_lshl_b32 s72, s72, 10
  s_mov_b32 s79, 4
  s_setprio 2
  s_mov_b32 s77, 1
  s_branch L_FSP0
L_FSP:
  s_mov_b32 s70, 0
L_FSP_l:
  ds_read_b128 v[248:251], v246
  s_add_u32 s70, s70, 1
  s_waitcnt lgkmcnt(0)
  v_min_u32 v248, v248, v249
  v_min3_u32 v248, v248, v250, v251
  v_cmp_gt_u32 vcc, s77, v248
  s_cmp_lt_u32 s70, 0x400000
  s_cbranch_vccz L_FBK
  s_cbranch_scc1 L_FSP_l
  s_branch L_FBK
L_FSP0:
  s_mov_b32 s70, 0
L_FSP0_l:
  ds_read_b128 v[248:251], v246
  s_add_u32 s70, s70, 1
  s_waitcnt lgkmcnt(0)
  v_min_u32 v248, v248, v249
  v_min3_u32 v248, v248, v250, v251
  v_cmp_gt_u32 vcc, s77, v248
  s_cmp_lt_u32 s70, 0x400000
  s_cbranch_vccz L_FGO
  s_cbranch_scc1 L_FSP0_l
  s_branch L_FGO
L_FGO:
  ds_read_b128 v[144:147], v240 offset:0
  ds_read_b64_tr_b16 v[192:193], v242 offset:0
  ds_read_b64_tr_b16 v[194:195], v242 offset:768
  ds_read_b64_tr_b16 v[196:197], v242 offset:12288
  ds_read_b32 v247, v246
  ds_read_b64_tr_b16 v[198:199], v242 offset:13056
  ds_read_b64_tr_b16 v[200:201], v243 offset:0
  ds_read_b64_tr_b16 v[202:203], v243 offset:768
  ds_read_b64_tr_b16 v[204:205], v243 offset:12288
  ds_read_b64_tr_b16 v[206:207], v243 offset:13056
  ds_read_b64_tr_b16 v[208:209], v244 offset:0
  ds_read_b64_tr_b16 v[210:211], v244 offset:768
  ds_read_b64_tr_b16 v[212:213], v244 offset:12288
  ds_read_b64_tr_b16 v[214:215], v244 offset:13056
  ds_read_b128 v[148:151], v240 offset:2048
  ds_read_b128 v[152:155], v240 offset:4096
  ds_read_b128 v[156:159], v240 offset:6144
  ds_read_b128 v[160:163], v240 offset:8192
  ds_read_b128 v[164:167], v240 offset:10240
L_FLOOP:
  s_waitcnt lgkmcnt(5)
  v_mfma_f32_16x16x32_bf16 v[0:3], v[192:195], v[144:147], v[0:3]
  v_mfma_f32_16x16x32_bf16 v[8:11], v[196:199], v[144:147], v[8:11]
  ds_read_b128 v[168:171], v241 offset:0
  v_mfma_f32_16x16x32_bf16 v[16:19], v[200:203], v[144:147], v[16:19]
  v_mfma_f32_16x16x32_bf16 v[24:27], v[204:207], v[144:147], v[24:27]
  ds_read_b64_tr_b16 v[216:217], v242 offset:6144
  v_mfma_f32_16x16x32_bf16 v[32:35], v[208:211], v[144:147], v[32:35]
  v_mfma_f32_16x16x32_bf16 v[40:43], v[212:215], v[144:147], v[40:43]
  ds_read_b64_tr_b16 v[218:219], v242 offset:6912
  s_waitcnt lgkmcnt(6)
  v_mfma_f32_16x16x32_bf16 v[4:7], v[192:195], v[148:151], v[4:7]
  v_mfma_f32_16x16x32_bf16 v[12:15], v[196:199], v[148:151], v[12:15]
  ds_read_b64_tr_b16 v[220:221], v242 offset:18432
  v_mfma_f32_16x16x32_bf16 v[20:23], v[200:203], v[148:151], v[20:23]
  v_mfma_f32_16x16x32_bf16 v[28:31], v[204:207], v[148:151], v[28:31]
  ds_read_b64_tr_b16 v[222:223], v242 offset:19200
  v_mfma_f32_16x16x32_bf16 v[36:39], v[208:211], v[148:151], v[36:39]
  v_mfma_f32_16x16x32_bf16 v[44:47], v[212:215], v[148:151], v[44:47]
  ds_read_b64_tr_b16 v[224:225], v243 offset:6144
  v_mfma_f32_16x16x32_bf16 v[48:51], v[192:195], v[152:155], v[48:51]
  v_mfma_f32_16x16x32_bf16 v[56:59], v[196:199], v[152:155], v[56:59]
  ds_read_b64_tr_b16 v[226:227], v243 offset:6912
  v_mfma_f32_16x16x32_bf16 v[64:67], v[200:203], v[152:155], v[64:67]
  v_mfma_f32_16x16x32_bf16 v[72:75], v[204:207], v[152:155], v[72:75]
  ds_read_b64_tr_b16 v[228:229], v243 offset:18432
  v_mfma_f32_16x16x32_bf16 v[80:83], v[208:211], v[152:155], v[80:83]
  v_mfma_f32_16x16x32_bf16 v[88:91], v[212:215], v[152:155], v[88:91]
  ds_read_b64_tr_b16 v[230:231], v243 offset:19200
  s_waitcnt lgkmcnt(9)
  v_mfma_f32_16x16x32_bf16 v[52:55], v[192:195], v[156:159], v[52:55]
  ds_read_b128 v[248:251], v246
  v_mfma_f32_16x16x32_bf16 v[60:63], v[196:199], v[156:159], v[60:63]
  ds_read_b64_tr_b16 v[232:233], v244 offset:6144
  v_mfma_f32_16x16x32_bf16 v[68:71], v[200:203], v[156:159], v[68:71]
  s_add_u32 s77, s77, 1
  s_add_u32 s78, s78, 1
  v_mfma_f32_16x16x32_bf16 v[76:79], v[204:207], v[156:159], v[76:79]
  ds_read_b64_tr_b16 v[234:235], v244 offset:6912
  v_mfma_f32_16x16x32_bf16 v[84:87], v[208:211], v[156:159], v[84:87]
  s_mov_b32 s76, 51200
  s_cmp_eq_u32 s78, 3
  v_mfma_f32_16x16x32_bf16 v[92:95], v[212:215], v[156:159], v[92:95]
  ds_read_b64_tr_b16 v[236:237], v244 offset:18432
  v_mfma_f32_16x16x32_bf16 v[96:99], v[192:195], v[160:163], v[96:99]
  s_cmov_b32 s76, -102400
  s_cmov_b32 s78, 0
  v_mfma_f32_16x16x32_bf16 v[104:107], v[196:199], v[160:163], v[104:107]
  ds_read_b64_tr_b16 v[238:239], v244 offset:19200
  v_mfma_f32_16x16x32_bf16 v[112:115], v[200:203], v[160:163], v[112:115]
  v_add_u32 v240, s76, v240
  v_add_u32 v242, s76, v242
  v_mfma_f32_16x16x32_bf16 v[120:123], v[204:207], v[160:163], v[120:123]
  ds_read_b128 v[172:175], v241 offset:2048
  v_mfma_f32_16x16x32_bf16 v[128:131], v[208:211], v[160:163], v[128:131]
  s_waitcnt lgkmcnt(5)
  v_mfma_f32_16x16x32_bf16 v[136:139], v[212:215], v[160:163], v[136:139]
  ds_read_b128 v[176:179], v241 offset:4096
  v_mfma_f32_16x16x32_bf16 v[100:103], v[192:195], v[164:167], v[100:103]
  v_min_u32 v248, v248, v249
  v_mfma_f32_16x16x32_bf16 v[108:111], v[196:199], v[164:167], v[108:111]
  ds_read_b128 v[180:183], v241 offset:6144
  v_mfma_f32_16x16x32_bf16 v[116:119], v[200:203], v[164:167], v[116:119]
  v_min3_u32 v248, v248, v250, v251
  v_mfma_f32_16x16x32_bf16 v[124:127], v[204:207], v[164:167], v[124:127]
  ds_read_b128 v[184:187], v241 offset:8192
  v_mfma_f32_16x16x32_bf16 v[132:135], v[208:211], v[164:167], v[132:135]
  v_cmp_gt_u32 vcc, s77, v248
  v_mfma_f32_16x16x32_bf16 v[140:143], v[212:215], v[164:167], v[140:143]
  ds_read_b128 v[188:191], v241 offset:10240
  s_waitcnt lgkmcnt(5)
  v_mfma_f32_16x16x32_bf16 v[0:3], v[216:219], v[168:171], v[0:3]
  s_cbranch_vccnz L_FSP
L_FBK:
  v_mfma_f32_16x16x32_bf16 v[8:11], v[220:223], v[168:171], v[8:11]
  ds_read_b128 v[144:147], v240 offset:0
  v_mfma_f32_16x16x32_bf16 v[16:19], v[224:227], v[168:171], v[16:19]
  v_add_u32 v243, s76, v243
  v_add_u32 v244, s76, v244
  v_mfma_f32_16x16x32_bf16 v[24:27], v[228:231], v[168:171], v[24:27]
  ds_read_b64_tr_b16 v[192:193], v242 offset:0
  v_mfma_f32_16x16x32_bf16 v[32:35], v[232:235], v[168:171], v[32:35]
  v_add_u32 v241, s76, v241
  v_mfma_f32_16x16x32_bf16 v[40:43], v[236:239], v[168:171], v[40:43]
  ds_read_b64_tr_b16 v[194:195], v242 offset:768
  s_waitcnt lgkmcnt(6)
  v_mfma_f32_16x16x32_bf16 v[4:7], v[216:219], v[172:175], v[4:7]
  v_add_u32_e64 v247, -1, s77
  v_mfma_f32_16x16x32_bf16 v[12:15], v[220:223], v[172:175], v[12:15]
  ds_read_b64_tr_b16 v[196:197], v242 offset:12288
  v_mfma_f32_16x16x32_bf16 v[20:23], v[224:227], v[172:175], v[20:23]
  s_waitcnt lgkmcnt(4)
  ds_write_b32 v245, v247 offset:16
  v_mfma_f32_16x16x32_bf16 v[28:31], v[228:231], v[172:175], v[28:31]
  ds_read_b64_tr_b16 v[198:199], v242 offset:13056
  v_mfma_f32_16x16x32_bf16 v[36:39], v[232:235], v[172:175], v[36:39]
  v_mfma_f32_16x16x32_bf16 v[44:47], v[236:239], v[172:175], v[44:47]
  ds_read_b64_tr_b16 v[200:201], v243 offset:0
  v_mfma_f32_16x16x32_bf16 v[48:51], v[216:219], v[176:179], v[48:51]
  v_mfma_f32_16x16x32_bf16 v[56:59], v[220:223], v[176:179], v[56:59]
  ds_read_b64_tr_b16 v[202:203], v243 offset:768
  v_mfma_f32_16x16x32_bf16 v[64:67], v[224:227], v[176:179], v[64:67]
  v_mfma_f32_16x16x32_bf16 v[72:75], v[228:231], v[176:179], v[72:75]
  ds_read_b64_tr_b16 v[204:205], v243 offset:12288
  v_mfma_f32_16x16x32_bf16 v[80:83], v[232:235], v[176:179], v[80:83]
  v_mfma_f32_16x16x32_bf16 v[88:91], v[236:239], v[176:179], v[88:91]
  ds_read_b64_tr_b16 v[206:207], v243 offset:13056
  v_mfma_f32_16x16x32_bf16 v[52:55], v[216:219], v[180:183], v[52:55]
  v_mfma_f32_16x16x32_bf16 v[60:63], v[220:223], v[180:183], v[60:63]
  ds_read_b64_tr_b16 v[208:209], v244 offset:0
  v_mfma_f32_16x16x32_bf16 v[68:71], v[224:227], v[180:183], v[68:71]
  v_mfma_f32_16x16x32_bf16 v[76:79], v[228:231], v[180:183], v[76:79]
  ds_read_b64_tr_b16 v[210:211], v244 offset:768
  v_mfma_f32_16x16x32_bf16 v[84:87], v[232:235], v[180:183], v[84:87]
  v_mfma_f32_16x16x32_bf16 v[92:95], v[236:239], v[180:183], v[92:95]
  ds_read_b64_tr_b16 v[212:213], v244 offset:12288
  v_mfma_f32_16x16x32_bf16 v[96:99], v[216:219], v[184:187], v[96:99]
  v_mfma_f32_16x16x32_bf16 v[104:107], v[220:223], v[184:187], v[104:107]
  ds_read_b64_tr_b16 v[214:215], v244 offset:13056
  v_mfma_f32_16x16x32_bf16 v[112:115], v[224:227], v[184:187], v[112:115]
  v_mfma_f32_16x16x32_bf16 v[120:123], v[228:231], v[184:187], v[120:123]
  ds_read_b128 v[148:151], v240 offset:2048
  v_mfma_f32_16x16x32_bf16 v[128:131], v[232:235], v[184:187], v[128:131]
  v_mfma_f32_16x16x32_bf16 v[136:139], v[236:239], v[184:187], v[136:139]
  ds_read_b128 v[152:155], v240 offset:4096
  v_mfma_f32_16x16x32_bf16 v[100:103], v[216:219], v[188:191], v[100:103]
  v_mfma_f32_16x16x32_bf16 v[108:111], v[220:223], v[188:191], v[108:111]
  ds_read_b128 v[156:159], v240 offset:6144
  v_mfma_f32_16x16x32_bf16 v[116:119], v[224:227], v[188:191], v[116:119]
  v_mfma_f32_16x16x32_bf16 v[124:127], v[228:231], v[188:191], v[124:127]
  ds_read_b128 v[160:163], v240 offset:8192
  v_mfma_f32_16x16x32_bf16 v[132:135], v[232:235], v[188:191], v[132:135]
  v_mfma_f32_16x16x32_bf16 v[140:143], v[236:239], v[188:191], v[140:143]
  ds_read_b128 v[164:167], v240 offset:10240
  s_cmp_lt_u32 s77, 9
  s_cbranch_scc1 L_FLOOP
L_WF_0:
  s_cbranch_execz L_WF_1
  s_waitcnt lgkmcnt(0)
  s_lshr_b32 s66, s56, 1
  s_and_b32 s67, s56, 1
  s_mul_i32 s68, s66, 1536
  s_add_u32 s68, s68, 155648
  v_and_b32 v204, 15, v254
  v_lshl_add_u32 v204, v204, 4, s68
  s_mul_i32 s68, s67, 192
  s_add_u32 s68, s68, 161792
  v_and_b32 v205, 48, v254
  v_add_u32 v205, s68, v205
  ds_read_b128 v[144:147], v204 offset:0
  ds_read_b128 v[148:151], v204 offset:256
  ds_read_b128 v[168:171], v205 offset:0
  ds_read_b128 v[172:175], v205 offset:512
  ds_read_b128 v[152:155], v204 offset:512
  ds_read_b128 v[156:159], v204 offset:768
  ds_read_b128 v[160:163], v204 offset:1024
  ds_read_b128 v[164:167], v204 offset:1280
  ds_read_b128 v[176:179], v205 offset:64
  ds_read_b128 v[180:183], v205 offset:576
  ds_read_b128 v[184:187], v205 offset:128
  ds_read_b128 v[188:191], v205 offset:640
  v_mov_b32 v247, 159728
  ds_read_b64 v[248:249], v247
  v_lshlrev_b32 v206, 4, v254
  s_waitcnt lgkmcnt(9)
  v_pk_fma_f32 v[0:1], v[168:169], v[144:145], v[0:1] op_sel_hi:[1,0,1] neg_lo:[0,1,0] neg_hi:[0,1,0]
  v_pk_fma_f32 v[2:3], v[170:171], v[144:145], v[2:3] op_sel_hi:[1,0,1] neg_lo:[0,1,0] neg_hi:[0,1,0]
  v_pk_fma_f32 v[4:5], v[168:169], v[148:149], v[4:5] op_sel_hi:[1,0,1] neg_lo:[0,1,0] neg_hi:[0,1,0]
  v_pk_fma_f32 v[6:7], v[170:171], v[148:149], v[6:7] op_sel_hi:[1,0,1] neg_lo:[0,1,0] neg_hi:[0,1,0]
  v_pk_mul_f32 v[208:209], v[0:1], v[146:147] op_sel:[0,1] op_sel_hi:[1,1]
  v_pk_mul_f32 v[210:211], v[2:3], v[146:147] op_sel:[0,1] op_sel_hi:[1,1]
  v_pk_mul_f32 v[212:213], v[4:5], v[150:151] op_sel:[0,1] op_sel_hi:[1,1]
  v_pk_mul_f32 v[214:215], v[6:7], v[150:151] op_sel:[0,1] op_sel_hi:[1,1]
  v_exp_f32 v208, v208
  v_exp_f32 v209, v209
  v_pk_fma_f32 v[8:9], v[172:173], v[144:145], v[8:9] op_sel_hi:[1,0,1] neg_lo:[0,1,0] neg_hi:[0,1,0]
  v_pk_fma_f32 v[10:11], v[174:175], v[144:145], v[10:11] op_sel_hi:[1,0,1] neg_lo:[0,1,0] neg_hi:[0,1,0]
L_WF_1:
  s_cbranch_execz L_WF_2
  v_exp_f32 v210, v210
  v_exp_f32 v211, v211
  v_pk_fma_f32 v[12:13], v[172:173], v[148:149], v[12:13] op_sel_hi:[1,0,1] neg_lo:[0,1,0] neg_hi:[0,1,0]
  v_pk_fma_f32 v[14:15], v[174:175], v[148:149], v[14:15] op_sel_hi:[1,0,1] neg_lo:[0,1,0] neg_hi:[0,1,0]
  v_exp_f32 v212, v212
  v_exp_f32 v213, v213
  v_pk_mul_f32 v[8:9], v[8:9], v[0:1]
  v_pk_mul_f32 v[10:11], v[10:11], v[2:3]
  v_exp_f32 v214, v214
  v_exp_f32 v215, v215
  v_pk_mul_f32 v[12:13], v[12:13], v[4:5]
  v_pk_mul_f32 v[14:15], v[14:15], v[6:7]
  v_pk_fma_f32 v[208:209], v[208:209], v[146:147], v[146:147] op_sel_hi:[1,0,0]
  v_pk_fma_f32 v[210:211], v[210:211], v[146:147], v[146:147] op_sel_hi:[1,0,0]
  v_pk_fma_f32 v[212:213], v[212:213], v[150:151], v[150:151] op_sel_hi:[1,0,0]
  v_pk_fma_f32 v[214:215], v[214:215], v[150:151], v[150:151] op_sel_hi:[1,0,0]
  s_waitcnt lgkmcnt(0)
  v_rcp_f32 v208, v208
  v_rcp_f32 v209, v209
  v_pk_fma_f32 v[48:49], v[168:169], v[152:153], v[48:49] op_sel_hi:[1,0,1] neg_lo:[0,1,0] neg_hi:[0,1,0]
  v_pk_fma_f32 v[50:51], v[170:171], v[152:153], v[50:51] op_sel_hi:[1,0,1] neg_lo:[0,1,0] neg_hi:[0,1,0]
  v_rcp_f32 v210, v210
  v_rcp_f32 v211, v211
  v_pk_fma_f32 v[52:53], v[168:169], v[156:157], v[52:53] op_sel_hi:[1,0,1] neg_lo:[0,1,0] neg_hi:[0,1,0]
  v_pk_fma_f32 v[54:55], v[170:171], v[156:157], v[54:55] op_sel_hi:[1,0,1] neg_lo:[0,1,0] neg_hi:[0,1,0]
  v_rcp_f32 v212, v212
  v_rcp_f32 v213, v213
  v_pk_mul_f32 v[216:217], v[48:49], v[154:155] op_sel:[0,1] op_sel_hi:[1,1]
  v_pk_mul_f32 v[218:219], v[50:51], v[154:155] op_sel:[0,1] op_sel_hi:[1,1]
  v_rcp_f32 v214, v214
  v_rcp_f32 v215, v215
  v_pk_mul_f32 v[220:221], v[52:53], v[158:159] op_sel:[0,1] op_sel_hi:[1,1]
  v_pk_mul_f32 v[222:223], v[54:55], v[158:159] op_sel:[0,1] op_sel_hi:[1,1]
  v_pk_mul_f32 v[8:9], v[8:9], v[208:209]
  v_pk_mul_f32 v[12:13], v[12:13], v[212:213]
  v_pk_mul_f32 v[10:11], v[10:11], v[210:211]
  v_pk_mul_f32 v[14:15], v[14:15], v[214:215]
  v_cvt_pk_bf16_f32 v192, v8, v9
  v_cvt_pk_bf16_f32 v194, v12, v13
L_WF_2:
  s_cbranch_execz L_WF_3
  v_cvt_pk_bf16_f32 v193, v10, v11
  v_cvt_pk_bf16_f32 v195, v14, v15
  v_permlane16_swap_b32 v192, v194
  s_nop 0
  v_permlane16_swap_b32 v193, v195
  s_add_u32 s70, s71, 0
  s_add_u32 s73, s72, 32768
  s_cmp_lt_u32 s70, 86
  s_cselect_b32 s73, s73, 2130706432
  buffer_store_dwordx4 v[192:195], v206, s[40:43], s73 offen sc1
  s_add_u32 s73, s73, 120832
  v_exp_f32 v216, v216
  v_exp_f32 v217, v217
  v_pk_fma_f32 v[56:57], v[172:173], v[152:153], v[56:57] op_sel_hi:[1,0,1] neg_lo:[0,1,0] neg_hi:[0,1,0]
  v_pk_fma_f32 v[58:59], v[174:175], v[152:153], v[58:59] op_sel_hi:[1,0,1] neg_lo:[0,1,0] neg_hi:[0,1,0]
  v_exp_f32 v218, v218
  v_exp_f32 v219, v219
  v_pk_fma_f32 v[60:61], v[172:173], v[156:157], v[60:61] op_sel_hi:[1,0,1] neg_lo:[0,1,0] neg_hi:[0,1,0]
  v_pk_fma_f32 v[62:63], v[174:175], v[156:157], v[62:63] op_sel_hi:[1,0,1] neg_lo:[0,1,0] neg_hi:[0,1,0]
  v_exp_f32 v220, v220
  v_exp_f32 v221, v221
  v_pk_mul_f32 v[56:57], v[56:57], v[48:49]
  v_pk_mul_f32 v[58:59], v[58:59], v[50:51]
  v_exp_f32 v222, v222
  v_exp_f32 v223, v223
  v_pk_mul_f32 v[60:61], v[60:61], v[52:53]
  v_pk_mul_f32 v[62:63], v[62:63], v[54:55]
  v_pk_fma_f32 v[216:217], v[216:217], v[154:155], v[154:155] op_sel_hi:[1,0,0]
  v_pk_fma_f32 v[218:219], v[218:219], v[154:155], v[154:155] op_sel_hi:[1,0,0]
  v_pk_fma_f32 v[220:221], v[220:221], v[158:159], v[158:159] op_sel_hi:[1,0,0]
  v_pk_fma_f32 v[222:223], v[222:223], v[158:159], v[158:159] op_sel_hi:[1,0,0]
  v_rcp_f32 v216, v216
  v_rcp_f32 v217, v217
  v_pk_fma_f32 v[96:97], v[168:169], v[160:161], v[96:97] op_sel_hi:[1,0,1] neg_lo:[0,1,0] neg_hi:[0,1,0]
  v_pk_fma_f32 v[98:99], v[170:171], v[160:161], v[98:99] op_sel_hi:[1,0,1] neg_lo:[0,1,0] neg_hi:[0,1,0]
  v_rcp_f32 v218, v218
  v_rcp_f32 v219, v219
  v_pk_fma_f32 v[100:101], v[168:169], v[164:165], v[100:101] op_sel_hi:[1,0,1] neg_lo:[0,1,0] neg_hi:[0,1,0]
  v_pk_fma_f32 v[102:103], v[170:171], v[164:165], v[102:103] op_sel_hi:[1,0,1] neg_lo:[0,1,0] neg_hi:[0,1,0]
  v_rcp_f32 v220, v220
  v_rcp_f32 v221, v221
  v_pk_mul_f32 v[208:209], v[96:97], v[162:163] op_sel:[0,1] op_sel_hi:[1,1]
  v_pk_mul_f32 v[210:211], v[98:99], v[162:163] op_sel:[0,1] op_sel_hi:[1,1]
L_WF_3:
  s_cbranch_execz L_WF_4
  v_rcp_f32 v222, v222
  v_rcp_f32 v223, v223
  v_pk_mul_f32 v[212:213], v[100:101], v[166:167] op_sel:[0,1] op_sel_hi:[1,1]
  v_pk_mul_f32 v[214:215], v[102:103], v[166:167] op_sel:[0,1] op_sel_hi:[1,1]
  v_pk_mul_f32 v[56:57], v[56:57], v[216:217]
  v_pk_mul_f32 v[60:61], v[60:61], v[220:221]
  v_pk_mul_f32 v[58:59], v[58:59], v[218:219]
  v_pk_mul_f32 v[62:63], v[62:63], v[222:223]
  v_cvt_pk_bf16_f32 v196, v56, v57
  v_cvt_pk_bf16_f32 v198, v60, v61
  v_cvt_pk_bf16_f32 v197, v58, v59
  v_cvt_pk_bf16_f32 v199, v62, v63
  v_permlane16_swap_b32 v196, v198
  s_nop 0
  v_permlane16_swap_b32 v197, v199
  buffer_store_dwordx4 v[196:199], v206, s[40:43], s73 offen sc1
  s_add_u32 s73, s73, 120832
  v_exp_f32 v208, v208
  v_exp_f32 v209, v209
  v_pk_fma_f32 v[104:105], v[172:173], v[160:161], v[104:105] op_sel_hi:[1,0,1] neg_lo:[0,1,0] neg_hi:[0,1,0]
  v_pk_fma_f32 v[106:107], v[174:175], v[160:161], v[106:107] op_sel_hi:[1,0,1] neg_lo:[0,1,0] neg_hi:[0,1,0]
  v_exp_f32 v210, v210
  v_exp_f32 v211, v211
  v_pk_fma_f32 v[108:109], v[172:173], v[164:165], v[108:109] op_sel_hi:[1,0,1] neg_lo:[0,1,0] neg_hi:[0,1,0]
  v_pk_fma_f32 v[110:111], v[174:175], v[164:165], v[110:111] op_sel_hi:[1,0,1] neg_lo:[0,1,0] neg_hi:[0,1,0]
  v_exp_f32 v212, v212
  v_exp_f32 v213, v213
  v_pk_mul_f32 v[104:105], v[104:105], v[96:97]
  v_pk_mul_f32 v[106:107], v[106:107], v[98:99]
  v_exp_f32 v214, v214
  v_exp_f32 v215, v215
  v_pk_mul_f32 v[108:109], v[108:109], v[100:101]
  v_pk_mul_f32 v[110:111], v[110:111], v[102:103]
  v_pk_fma_f32 v[208:209], v[208:209], v[162:163], v[162:163] op_sel_hi:[1,0,0]
  v_pk_fma_f32 v[210:211], v[210:211], v[162:163], v[162:163] op_sel_hi:[1,0,0]
  v_pk_fma_f32 v[212:213], v[212:213], v[166:167], v[166:167] op_sel_hi:[1,0,0]
  v_pk_fma_f32 v[214:215], v[214:215], v[166:167], v[166:167] op_sel_hi:[1,0,0]
  v_rcp_f32 v208, v208
  v_rcp_f32 v209, v209
  v_pk_fma_f32 v[16:17], v[176:177], v[144:145], v[16:17] op_sel_hi:[1,0,1] neg_lo:[0,1,0] neg_hi:[0,1,0]
L_WF_4:
  s_cbranch_execz L_WF_5
  v_pk_fma_f32 v[18:19], v[178:179], v[144:145], v[18:19] op_sel_hi:[1,0,1] neg_lo:[0,1,0] neg_hi:[0,1,0]
  v_rcp_f32 v210, v210
  v_rcp_f32 v211, v211
  v_pk_fma_f32 v[20:21], v[176:177], v[148:149], v[20:21] op_sel_hi:[1,0,1] neg_lo:[0,1,0] neg_hi:[0,1,0]
  v_pk_fma_f32 v[22:23], v[178:179], v[148:149], v[22:23] op_sel_hi:[1,0,1] neg_lo:[0,1,0] neg_hi:[0,1,0]
  v_rcp_f32 v212, v212
  v_rcp_f32 v213, v213
  v_pk_mul_f32 v[216:217], v[16:17], v[146:147] op_sel:[0,1] op_sel_hi:[1,1]
  v_pk_mul_f32 v[218:219], v[18:19], v[146:147] op_sel:[0,1] op_sel_hi:[1,1]
  v_rcp_f32 v214, v214
  v_rcp_f32 v215, v215
  v_pk_mul_f32 v[220:221], v[20:21], v[150:151] op_sel:[0,1] op_sel_hi:[1,1]
  v_pk_mul_f32 v[222:223], v[22:23], v[150:151] op_sel:[0,1] op_sel_hi:[1,1]
  v_pk_mul_f32 v[104:105], v[104:105], v[208:209]
  v_pk_mul_f32 v[108:109], v[108:109], v[212:213]
  v_pk_mul_f32 v[106:107], v[106:107], v[210:211]
  v_pk_mul_f32 v[110:111], v[110:111], v[214:215]
  v_cvt_pk_bf16_f32 v192, v104, v105
  v_cvt_pk_bf16_f32 v194, v108, v109
  v_cvt_pk_bf16_f32 v193, v106, v107
  v_cvt_pk_bf16_f32 v195, v110, v111
  v_permlane16_swap_b32 v192, v194
  s_nop 0
  v_permlane16_swap_b32 v193, v195
  buffer_store_dwordx4 v[192:195], v206, s[40:43], s73 offen sc1
  v_exp_f32 v216, v216
  v_exp_f32 v217, v217
  v_pk_fma_f32 v[24:25], v[180:181], v[144:145], v[24:25] op_sel_hi:[1,0,1] neg_lo:[0,1,0] neg_hi:[0,1,0]
  v_pk_fma_f32 v[26:27], v[182:183], v[144:145], v[26:27] op_sel_hi:[1,0,1] neg_lo:[0,1,0] neg_hi:[0,1,0]
  v_exp_f32 v218, v218
  v_exp_f32 v219, v219
  v_pk_fma_f32 v[28:29], v[180:181], v[148:149], v[28:29] op_sel_hi:[1,0,1] neg_lo:[0,1,0] neg_hi:[0,1,0]
  v_pk_fma_f32 v[30:31], v[182:183], v[148:149], v[30:31] op_sel_hi:[1,0,1] neg_lo:[0,1,0] neg_hi:[0,1,0]
  v_exp_f32 v220, v220
  v_exp_f32 v221, v221
  v_pk_mul_f32 v[24:25], v[24:25], v[16:17]
  v_pk_mul_f32 v[26:27], v[26:27], v[18:19]
  v_exp_f32 v222, v222
  v_exp_f32 v223, v223
  v_pk_mul_f32 v[28:29], v[28:29], v[20:21]
L_WF_5:
  s_cbranch_execz L_WF_6
  v_pk_mul_f32 v[30:31], v[30:31], v[22:23]
  v_pk_fma_f32 v[216:217], v[216:217], v[146:147], v[146:147] op_sel_hi:[1,0,0]
  v_pk_fma_f32 v[218:219], v[218:219], v[146:147], v[146:147] op_sel_hi:[1,0,0]
  v_pk_fma_f32 v[220:221], v[220:221], v[150:151], v[150:151] op_sel_hi:[1,0,0]
  v_pk_fma_f32 v[222:223], v[222:223], v[150:151], v[150:151] op_sel_hi:[1,0,0]
  v_rcp_f32 v216, v216
  v_rcp_f32 v217, v217
  v_pk_fma_f32 v[64:65], v[176:177], v[152:153], v[64:65] op_sel_hi:[1,0,1] neg_lo:[0,1,0] neg_hi:[0,1,0]
  v_pk_fma_f32 v[66:67], v[178:179], v[152:153], v[66:67] op_sel_hi:[1,0,1] neg_lo:[0,1,0] neg_hi:[0,1,0]
  v_rcp_f32 v218, v218
  v_rcp_f32 v219, v219
  v_pk_fma_f32 v[68:69], v[176:177], v[156:157], v[68:69] op_sel_hi:[1,0,1] neg_lo:[0,1,0] neg_hi:[0,1,0]
  v_pk_fma_f32 v[70:71], v[178:179], v[156:157], v[70:71] op_sel_hi:[1,0,1] neg_lo:[0,1,0] neg_hi:[0,1,0]
  v_rcp_f32 v220, v220
  v_rcp_f32 v221, v221
  v_pk_mul_f32 v[208:209], v[64:65], v[154:155] op_sel:[0,1] op_sel_hi:[1,1]
  v_pk_mul_f32 v[210:211], v[66:67], v[154:155] op_sel:[0,1] op_sel_hi:[1,1]
  v_rcp_f32 v222, v222
  v_rcp_f32 v223, v223
  v_pk_mul_f32 v[212:213], v[68:69], v[158:159] op_sel:[0,1] op_sel_hi:[1,1]
  v_pk_mul_f32 v[214:215], v[70:71], v[158:159] op_sel:[0,1] op_sel_hi:[1,1]
  v_pk_mul_f32 v[24:25], v[24:25], v[216:217]
  v_pk_mul_f32 v[28:29], v[28:29], v[220:221]
  v_pk_mul_f32 v[26:27], v[26:27], v[218:219]
  v_pk_mul_f32 v[30:31], v[30:31], v[222:223]
  v_cvt_pk_bf16_f32 v196, v24, v25
  v_cvt_pk_bf16_f32 v198, v28, v29
  v_cvt_pk_bf16_f32 v197, v26, v27
  v_cvt_pk_bf16_f32 v199, v30, v31
  v_permlane16_swap_b32 v196, v198
  s_nop 0
  v_permlane16_swap_b32 v197, v199
  s_add_u32 s70, s71, 1
  s_add_u32 s73, s72, 33792
  s_cmp_lt_u32 s70, 86
  s_cselect_b32 s73, s73, 2130706432
  buffer_store_dwordx4 v[196:199], v206, s[40:43], s73 offen sc1
  s_add_u32 s73, s73, 120832
  v_exp_f32 v208, v208
  v_exp_f32 v209, v209
  v_pk_fma_f32 v[72:73], v[180:181], v[152:153], v[72:73] op_sel_hi:[1,0,1] neg_lo:[0,1,0] neg_hi:[0,1,0]
L_WF_6:
  s_cbranch_execz L_WRET
  v_pk_fma_f32 v[74:75], v[182:183], v[152:153], v[74:75] op_sel_hi:[1,0,1] neg_lo:[0,1,0] neg_hi:[0,1,0]
  v_exp_f32 v210, v210
  v_exp_f32 v211, v211
  v_pk_fma_f32 v[76:77], v[180:181], v[156:157], v[76:77] op_sel_hi:[1,0,1] neg_lo:[0,1,0] neg_hi:[0,1,0]
  v_pk_fma_f32 v[78:79], v[182:183], v[156:157], v[78:79] op_sel_hi:[1,0,1] neg_lo:[0,1,0] neg_hi:[0,1,0]
  v_exp_f32 v212, v212
  v_exp_f32 v213, v213
  v_pk_mul_f32 v[72:73], v[72:73], v[64:65]
  v_pk_mul_f32 v[74:75], v[74:75], v[66:67]
  v_exp_f32 v214, v214
  v_exp_f32 v215, v215
  v_pk_mul_f32 v[76:77], v[76:77], v[68:69]
  v_pk_mul_f32 v[78:79], v[78:79], v[70:71]
  v_pk_fma_f32 v[208:209], v[208:209], v[154:155], v[154:155] op_sel_hi:[1,0,0]
  v_pk_fma_f32 v[210:211], v[210:211], v[154:155], v[154:155] op_sel_hi:[1,0,0]
  v_pk_fma_f32 v[212:213], v[212:213], v[158:159], v[158:159] op_sel_hi:[1,0,0]
  v_pk_fma_f32 v[214:215], v[214:215], v[158:159], v[158:159] op_sel_hi:[1,0,0]
  v_rcp_f32 v208, v208
  v_rcp_f32 v209, v209
  v_pk_fma_f32 v[112:113], v[176:177], v[160:161], v[112:113] op_sel_hi:[1,0,1] neg_lo:[0,1,0] neg_hi:[0,1,0]
  v_pk_fma_f32 v[114:115], v[178:179], v[160:161], v[114:115] op_sel_hi:[1,0,1] neg_lo:[0,1,0] neg_hi:[0,1,0]
  v_rcp_f32 v210, v210
  v_rcp_f32 v211, v211
  v_pk_fma_f32 v[116:117], v[176:177], v[164:165], v[116:117] op_sel_hi:[1,0,1] neg_lo:[0,1,0] neg_hi:[0,1,0]
  v_pk_fma_f32 v[118:119], v[178:179], v[164:165], v[118:119] op_sel_hi:[1,0,1] neg_lo:[0,1,0] neg_hi:[0,1,0]
  v_rcp_f32 v212, v212
  v_rcp_f32 v213, v213
  v_pk_mul_f32 v[216:217], v[112:113], v[162:163] op_sel:[0,1] op_sel_hi:[1,1]
  v_pk_mul_f32 v[218:219], v[114:115], v[162:163] op_sel:[0,1] op_sel_hi:[1,1]
  v_rcp_f32 v214, v214
  v_rcp_f32 v215, v215
  v_pk_mul_f32 v[220:221], v[116:117], v[166:167] op_sel:[0,1] op_sel_hi:[1,1]
  v_pk_mul_f32 v[222:223], v[118:119], v[166:167] op_sel:[0,1] op_sel_hi:[1,1]
  v_pk_mul_f32 v[72:73], v[72:73], v[208:209]
  v_pk_mul_f32 v[76:77], v[76:77], v[212:213]
  v_pk_mul_f32 v[74:75], v[74:75], v[210:211]
  v_pk_mul_f32 v[78:79], v[78:79], v[214:215]
  v_cvt_pk_bf16_f32 v192, v72, v73
L_WF_7:
  s_cbranch_execz L_WF_8
  v_cvt_pk_bf16_f32 v194, v76, v77
  v_cvt_pk_bf16_f32 v193, v74, v75
  v_cvt_pk_bf16_f32 v195, v78, v79
  v_permlane16_swap_b32 v192, v194
  s_nop 0
  v_permlane16_swap_b32 v193, v195
  buffer_store_dwordx4 v[192:195], v206, s[40:43], s73 offen sc1
  s_add_u32 s73, s73, 120832
  v_exp_f32 v216, v216
  v_exp_f32 v217, v217
  v_pk_fma_f32 v[120:121], v[180:181], v[160:161], v[120:121] op_sel_hi:[1,0,1] neg_lo:[0,1,0] neg_hi:[0,1,0]
  v_pk_fma_f32 v[122:123], v[182:183], v[160:161], v[122:123] op_sel_hi:[1,0,1] neg_lo:[0,1,0] neg_hi:[0,1,0]
  v_exp_f32 v218, v218
  v_exp_f32 v219, v219
  v_pk_fma_f32 v[124:125], v[180:181], v[164:165], v[124:125] op_sel_hi:[1,0,1] neg_lo:[0,1,0] neg_hi:[0,1,0]
  v_pk_fma_f32 v[126:127], v[182:183], v[164:165], v[126:127] op_sel_hi:[1,0,1] neg_lo:[0,1,0] neg_hi:[0,1,0]
  v_exp_f32 v220, v220
  v_exp_f32 v221, v221
  v_pk_mul_f32 v[120:121], v[120:121], v[112:113]
  v_pk_mul_f32 v[122:123], v[122:123], v[114:115]
  v_exp_f32 v222, v222
  v_exp_f32 v223, v223
  v_pk_mul_f32 v[124:125], v[124:125], v[116:117]
  v_pk_mul_f32 v[126:127], v[126:127], v[118:119]
  v_pk_fma_f32 v[216:217], v[216:217], v[162:163], v[162:163] op_sel_hi:[1,0,0]
  v_pk_fma_f32 v[218:219], v[218:219], v[162:163], v[162:163] op_sel_hi:[1,0,0]
  v_pk_fma_f32 v[220:221], v[220:221], v[166:167], v[166:167] op_sel_hi:[1,0,0]
  v_pk_fma_f32 v[222:223], v[222:223], v[166:167], v[166:167] op_sel_hi:[1,0,0]
  v_rcp_f32 v216, v216
  v_rcp_f32 v217, v217
  v_pk_fma_f32 v[32:33], v[184:185], v[144:145], v[32:33] op_sel_hi:[1,0,1] neg_lo:[0,1,0] neg_hi:[0,1,0]
  v_pk_fma_f32 v[34:35], v[186:187], v[144:145], v[34:35] op_sel_hi:[1,0,1] neg_lo:[0,1,0] neg_hi:[0,1,0]
  v_rcp_f32 v218, v218
  v_rcp_f32 v219, v219
  v_pk_fma_f32 v[36:37], v[184:185], v[148:149], v[36:37] op_sel_hi:[1,0,1] neg_lo:[0,1,0] neg_hi:[0,1,0]
  v_pk_fma_f32 v[38:39], v[186:187], v[148:149], v[38:39] op_sel_hi:[1,0,1] neg_lo:[0,1,0] neg_hi:[0,1,0]
  v_rcp_f32 v220, v220
  v_rcp_f32 v221, v221
  v_pk_mul_f32 v[208:209], v[32:33], v[146:147] op_sel:[0,1] op_sel_hi:[1,1]
  v_pk_mul_f32 v[210:211], v[34:35], v[146:147] op_sel:[0,1] op_sel_hi:[1,1]
  v_rcp_f32 v222, v222
L_WF_8:
  s_cbranch_execz L_WF_9
  v_rcp_f32 v223, v223
  v_pk_mul_f32 v[212:213], v[36:37], v[150:151] op_sel:[0,1] op_sel_hi:[1,1]
  v_pk_mul_f32 v[214:215], v[38:39], v[150:151] op_sel:[0,1] op_sel_hi:[1,1]
  v_pk_mul_f32 v[120:121], v[120:121], v[216:217]
  v_pk_mul_f32 v[124:125], v[124:125], v[220:221]
  v_pk_mul_f32 v[122:123], v[122:123], v[218:219]
  v_pk_mul_f32 v[126:127], v[126:127], v[222:223]
  v_cvt_pk_bf16_f32 v196, v120, v121
  v_cvt_pk_bf16_f32 v198, v124, v125
  v_cvt_pk_bf16_f32 v197, v122, v123
  v_cvt_pk_bf16_f32 v199, v126, v127
  v_permlane16_swap_b32 v196, v198
  s_nop 0
  v_permlane16_swap_b32 v197, v199
  buffer_store_dwordx4 v[196:199], v206, s[40:43], s73 offen sc1
  v_exp_f32 v208, v208
  v_exp_f32 v209, v209
  v_pk_fma_f32 v[40:41], v[188:189], v[144:145], v[40:41] op_sel_hi:[1,0,1] neg_lo:[0,1,0] neg_hi:[0,1,0]
  v_pk_fma_f32 v[42:43], v[190:191], v[144:145], v[42:43] op_sel_hi:[1,0,1] neg_lo:[0,1,0] neg_hi:[0,1,0]
  v_exp_f32 v210, v210
  v_exp_f32 v211, v211
  v_pk_fma_f32 v[44:45], v[188:189], v[148:149], v[44:45] op_sel_hi:[1,0,1] neg_lo:[0,1,0] neg_hi:[0,1,0]
  v_pk_fma_f32 v[46:47], v[190:191], v[148:149], v[46:47] op_sel_hi:[1,0,1] neg_lo:[0,1,0] neg_hi:[0,1,0]
  v_exp_f32 v212, v212
  v_exp_f32 v213, v213
  v_pk_mul_f32 v[40:41], v[40:41], v[32:33]
  v_pk_mul_f32 v[42:43], v[42:43], v[34:35]
  v_exp_f32 v214, v214
  v_exp_f32 v215, v215
  v_pk_mul_f32 v[44:45], v[44:45], v[36:37]
  v_pk_mul_f32 v[46:47], v[46:47], v[38:39]
  v_pk_fma_f32 v[208:209], v[208:209], v[146:147], v[146:147] op_sel_hi:[1,0,0]
  v_pk_fma_f32 v[210:211], v[210:211], v[146:147], v[146:147] op_sel_hi:[1,0,0]
  v_pk_fma_f32 v[212:213], v[212:213], v[150:151], v[150:151] op_sel_hi:[1,0,0]
  v_pk_fma_f32 v[214:215], v[214:215], v[150:151], v[150:151] op_sel_hi:[1,0,0]
  v_rcp_f32 v208, v208
  v_rcp_f32 v209, v209
  v_pk_fma_f32 v[80:81], v[184:185], v[152:153], v[80:81] op_sel_hi:[1,0,1] neg_lo:[0,1,0] neg_hi:[0,1,0]
  v_pk_fma_f32 v[82:83], v[186:187], v[152:153], v[82:83] op_sel_hi:[1,0,1] neg_lo:[0,1,0] neg_hi:[0,1,0]
L_WF_9:
  s_cbranch_execz L_WF_10
  v_rcp_f32 v210, v210
  v_rcp_f32 v211, v211
  v_pk_fma_f32 v[84:85], v[184:185], v[156:157], v[84:85] op_sel_hi:[1,0,1] neg_lo:[0,1,0] neg_hi:[0,1,0]
  v_pk_fma_f32 v[86:87], v[186:187], v[156:157], v[86:87] op_sel_hi:[1,0,1] neg_lo:[0,1,0] neg_hi:[0,1,0]
  v_rcp_f32 v212, v212
  v_rcp_f32 v213, v213
  v_pk_mul_f32 v[216:217], v[80:81], v[154:155] op_sel:[0,1] op_sel_hi:[1,1]
  v_pk_mul_f32 v[218:219], v[82:83], v[154:155] op_sel:[0,1] op_sel_hi:[1,1]
  v_rcp_f32 v214, v214
  v_rcp_f32 v215, v215
  v_pk_mul_f32 v[220:221], v[84:85], v[158:159] op_sel:[0,1] op_sel_hi:[1,1]
  v_pk_mul_f32 v[222:223], v[86:87], v[158:159] op_sel:[0,1] op_sel_hi:[1,1]
  v_pk_mul_f32 v[40:41], v[40:41], v[208:209]
  v_pk_mul_f32 v[44:45], v[44:45], v[212:213]
  v_pk_mul_f32 v[42:43], v[42:43], v[210:211]
  v_pk_mul_f32 v[46:47], v[46:47], v[214:215]
  v_cvt_pk_bf16_f32 v192, v40, v41
  v_cvt_pk_bf16_f32 v194, v44, v45
  v_cvt_pk_bf16_f32 v193, v42, v43
  v_cvt_pk_bf16_f32 v195, v46, v47
  v_permlane16_swap_b32 v192, v194
  s_nop 0
  v_permlane16_swap_b32 v193, v195
  s_add_u32 s70, s71, 2
  s_add_u32 s73, s72, 34816
  s_cmp_lt_u32 s70, 86
  s_cselect_b32 s73, s73, 2130706432
  buffer_store_dwordx4 v[192:195], v206, s[40:43], s73 offen sc1
  s_add_u32 s73, s73, 120832
  v_exp_f32 v216, v216
  v_exp_f32 v217, v217
  v_pk_fma_f32 v[88:89], v[188:189], v[152:153], v[88:89] op_sel_hi:[1,0,1] neg_lo:[0,1,0] neg_hi:[0,1,0]
  v_pk_fma_f32 v[90:91], v[190:191], v[152:153], v[90:91] op_sel_hi:[1,0,1] neg_lo:[0,1,0] neg_hi:[0,1,0]
  v_exp_f32 v218, v218
  v_exp_f32 v219, v219
  v_pk_fma_f32 v[92:93], v[188:189], v[156:157], v[92:93] op_sel_hi:[1,0,1] neg_lo:[0,1,0] neg_hi:[0,1,0]
  v_pk_fma_f32 v[94:95], v[190:191], v[156:157], v[94:95] op_sel_hi:[1,0,1] neg_lo:[0,1,0] neg_hi:[0,1,0]
  v_exp_f32 v220, v220
  v_exp_f32 v221, v221
  v_pk_mul_f32 v[88:89], v[88:89], v[80:81]
  v_pk_mul_f32 v[90:91], v[90:91], v[82:83]
  v_exp_f32 v222, v222
L_WF_10:
  s_cbranch_execz L_WF_11
  v_exp_f32 v223, v223
  v_pk_mul_f32 v[92:93], v[92:93], v[84:85]
  v_pk_mul_f32 v[94:95], v[94:95], v[86:87]
  v_pk_fma_f32 v[216:217], v[216:217], v[154:155], v[154:155] op_sel_hi:[1,0,0]
  v_pk_fma_f32 v[218:219], v[218:219], v[154:155], v[154:155] op_sel_hi:[1,0,0]
  v_pk_fma_f32 v[220:221], v[220:221], v[158:159], v[158:159] op_sel_hi:[1,0,0]
  v_pk_fma_f32 v[222:223], v[222:223], v[158:159], v[158:159] op_sel_hi:[1,0,0]
  v_rcp_f32 v216, v216
  v_rcp_f32 v217, v217
  v_pk_fma_f32 v[128:129], v[184:185], v[160:161], v[128:129] op_sel_hi:[1,0,1] neg_lo:[0,1,0] neg_hi:[0,1,0]
  v_pk_fma_f32 v[130:131], v[186:187], v[160:161], v[130:131] op_sel_hi:[1,0,1] neg_lo:[0,1,0] neg_hi:[0,1,0]
  v_rcp_f32 v218, v218
  v_rcp_f32 v219, v219
  v_pk_fma_f32 v[132:133], v[184:185], v[164:165], v[132:133] op_sel_hi:[1,0,1] neg_lo:[0,1,0] neg_hi:[0,1,0]
  v_pk_fma_f32 v[134:135], v[186:187], v[164:165], v[134:135] op_sel_hi:[1,0,1] neg_lo:[0,1,0] neg_hi:[0,1,0]
  v_rcp_f32 v220, v220
  v_rcp_f32 v221, v221
  v_pk_mul_f32 v[208:209], v[128:129], v[162:163] op_sel:[0,1] op_sel_hi:[1,1]
  v_pk_mul_f32 v[210:211], v[130:131], v[162:163] op_sel:[0,1] op_sel_hi:[1,1]
  v_rcp_f32 v222, v222
  v_rcp_f32 v223, v223
  v_pk_mul_f32 v[212:213], v[132:133], v[166:167] op_sel:[0,1] op_sel_hi:[1,1]
  v_pk_mul_f32 v[214:215], v[134:135], v[166:167] op_sel:[0,1] op_sel_hi:[1,1]
  v_pk_mul_f32 v[88:89], v[88:89], v[216:217]
  v_pk_mul_f32 v[92:93], v[92:93], v[220:221]
  v_pk_mul_f32 v[90:91], v[90:91], v[218:219]
  v_pk_mul_f32 v[94:95], v[94:95], v[222:223]
  v_cvt_pk_bf16_f32 v196, v88, v89
  v_cvt_pk_bf16_f32 v198, v92, v93
  v_cvt_pk_bf16_f32 v197, v90, v91
  v_cvt_pk_bf16_f32 v199, v94, v95
  v_permlane16_swap_b32 v196, v198
  s_nop 0
  v_permlane16_swap_b32 v197, v199
  buffer_store_dwordx4 v[196:199], v206, s[40:43], s73 offen sc1
  s_add_u32 s73, s73, 120832
  v_exp_f32 v208, v208
  v_exp_f32 v209, v209
  v_pk_fma_f32 v[136:137], v[188:189], v[160:161], v[136:137] op_sel_hi:[1,0,1] neg_lo:[0,1,0] neg_hi:[0,1,0]
L_WF_11:
  s_cbranch_execz L_WF_12
  v_pk_fma_f32 v[138:139], v[190:191], v[160:161], v[138:139] op_sel_hi:[1,0,1] neg_lo:[0,1,0] neg_hi:[0,1,0]
  v_exp_f32 v210, v210
  v_exp_f32 v211, v211
  v_pk_fma_f32 v[140:141], v[188:189], v[164:165], v[140:141] op_sel_hi:[1,0,1] neg_lo:[0,1,0] neg_hi:[0,1,0]
  v_pk_fma_f32 v[142:143], v[190:191], v[164:165], v[142:143] op_sel_hi:[1,0,1] neg_lo:[0,1,0] neg_hi:[0,1,0]
  v_exp_f32 v212, v212
  v_exp_f32 v213, v213
  v_pk_mul_f32 v[136:137], v[136:137], v[128:129]
  v_pk_mul_f32 v[138:139], v[138:139], v[130:131]
  v_exp_f32 v214, v214
  v_exp_f32 v215, v215
  v_pk_mul_f32 v[140:141], v[140:141], v[132:133]
  v_pk_mul_f32 v[142:143], v[142:143], v[134:135]
  v_pk_fma_f32 v[208:209], v[208:209], v[162:163], v[162:163] op_sel_hi:[1,0,0]
  v_pk_fma_f32 v[210:211], v[210:211], v[162:163], v[162:163] op_sel_hi:[1,0,0]
  v_pk_fma_f32 v[212:213], v[212:213], v[166:167], v[166:167] op_sel_hi:[1,0,0]
  v_pk_fma_f32 v[214:215], v[214:215], v[166:167], v[166:167] op_sel_hi:[1,0,0]
  v_rcp_f32 v208, v208
  v_rcp_f32 v209, v209
  v_rcp_f32 v210, v210
  v_rcp_f32 v211, v211
  v_rcp_f32 v212, v212
  v_rcp_f32 v213, v213
  v_rcp_f32 v214, v214
  v_rcp_f32 v215, v215
  v_pk_mul_f32 v[136:137], v[136:137], v[208:209]
  v_pk_mul_f32 v[140:141], v[140:141], v[212:213]
  v_pk_mul_f32 v[138:139], v[138:139], v[210:211]
  v_pk_mul_f32 v[142:143], v[142:143], v[214:215]
  v_cvt_pk_bf16_f32 v192, v136, v137
  v_cvt_pk_bf16_f32 v194, v140, v141
  v_cvt_pk_bf16_f32 v193, v138, v139
  v_cvt_pk_bf16_f32 v195, v142, v143
  v_permlane16_swap_b32 v192, v194
  s_nop 0
  v_permlane16_swap_b32 v193, v195
  buffer_store_dwordx4 v[192:195], v206, s[40:43], s73 offen sc1
  s_mov_b64 exec, 1
  s_waitcnt vmcnt(0)
  buffer_store_dwordx2 v[248:249], v254, s[36:39], s74 offen sc1
  s_mov_b64 exec, -1
  v_readfirstlane_b32 s64, v248
L_WF_12:
  s_cbranch_execz L_WF_13
  v_readfirstlane_b32 s65, v249
  s_lshl_b32 s66, s56, 2
  s_add_u32 s66, s66, 159712
  v_mov_b32 v250, s66
  v_mov_b32 v251, 9
  ds_write_b32 v250, v251
  s_setprio 0
  v_lshlrev_b32 v246, 4, v254
  v_add_u32 v240, s95, v246
  v_add_u32 v241, 0x10000, v240
  v_add_u32 v242, 0x20000, v240
  s_lshl_b32 s66, s60, 2
  s_add_u32 s66, s66, 159696
  v_mov_b32 v238, s66
  s_mov_b32 s70, 0
L_pw_82:
  ds_read_b32 v239, v238
  s_add_u32 s70, s70, 1
  s_waitcnt lgkmcnt(0)
  v_cmp_gt_u32 vcc, 10, v239
  s_cmp_lt_u32 s70, 0x400000
  s_cbranch_vccz L_pwd_83
  s_cbranch_scc1 L_pw_82
L_pwd_83:
  s_add_u32 s68, s91, 6
  s_cmp_ge_u32 s68, s92
  s_cselect_b32 s66, s92, 0
  s_sub_u32 s68, s68, s66
  s_add_u32 s66, s93, s68
  s_lshl_b32 s66, s66, 11
  buffer_load_dwordx4 v[192:195], v246, s[36:39], s66 offen sc1
  buffer_load_dwordx4 v[196:199], v246, s[36:39], s66 offen offset:1024 sc1
  s_add_u32 s68, s91, 7
  s_cmp_ge_u32 s68, s92
  s_cselect_b32 s66, s92, 0
  s_sub_u32 s68, s68, s66
  s_add_u32 s66, s93, s68
  s_lshl_b32 s66, s66, 11
  buffer_load_dwordx4 v[200:203], v246, s[36:39], s66 offen sc1
  buffer_load_dwordx4 v[204:207], v246, s[36:39], s66 offen offset:1024 sc1
  s_add_u32 s68, s91, 8
  s_cmp_ge_u32 s68, s92
  s_cselect_b32 s66, s92, 0
  s_sub_u32 s68, s68, s66
  s_add_u32 s66, s93, s68
  s_lshl_b32 s66, s66, 11
  buffer_load_dwordx4 v[208:211], v246, s[36:39], s66 offen sc1
  buffer_load_dwordx4 v[212:215], v246, s[36:39], s66 offen offset:1024 sc1
  s_add_u32 s68, s91, 9
  s_cmp_ge_u32 s68, s92
  s_cselect_b32 s66, s92, 0
  s_sub_u32 s68, s68, s66
  s_add_u32 s66, s93, s68
  s_lshl_b32 s66, s66, 11
L_WF_13:
  s_cbranch_execz L_WRET
  buffer_load_dwordx4 v[216:219], v246, s[36:39], s66 offen sc1
  buffer_load_dwordx4 v[220:223], v246, s[36:39], s66 offen offset:1024 sc1
  s_branch L_P2
L_CQ:
  v_and_b32 v160, 15, v254
  v_bfe_u32 v161, v254, 1, 3
  v_lshrrev_b32 v162, 4, v254
  v_xor_b32 v161, v161, v162
  v_lshlrev_b32 v163, 7, v160
  v_lshl_add_u32 v240, v161, 4, v163
  v_xor_b32 v241, 64, v240
  v_bfe_u32 v163, v254, 2, 2
  v_lshl_add_u32 v163, v162, 3, v163
  v_lshlrev_b32 v163, 7, v163
  v_bfe_u32 v164, v254, 3, 1
  v_and_b32 v165, 1, v162
  v_lshl_or_b32 v164, v165, 1, v164
  v_xor_b32 v164, s56, v164
  v_lshl_add_u32 v163, v164, 5, v163
  v_and_b32 v164, 3, v254
  v_lshl_add_u32 v163, v164, 3, v163
  v_add_u32 v244, 26624, v163
  v_and_b32 v164, 1, v254
  v_cmp_eq_u32 s[80:81], 1, v164
  v_lshl_add_u32 v165, v162, 2, v164
  v_cmp_le_u32 s[82:83], v165, v160
  v_add_u32 v165, 2, v165
  v_cmp_le_u32 s[84:85], v165, v160
  s_cmp_eq_u32 s57, 0
  s_cselect_b64 s[86:87], s[82:83], -1
  s_cselect_b64 s[88:89], s[84:85], -1
  v_mov_b32 v163, 0x0c0c0100
  v_mov_b32 v164, 0x01000c0c
  v_cndmask_b32 v163, v163, v164, s[80:81]
  v_mov_b32 v164, 0x0c0c0302
  v_mov_b32 v165, 0x03020c0c
  v_cndmask_b32 v164, v164, v165, s[80:81]
  v_mov_b32 v165, 0x0c0c0c0c
  v_cndmask_b32 v242, v163, v165, s[82:83]
  v_cndmask_b32 v243, v164, v165, s[84:85]
  v_cndmask_b32 v252, v165, v163, s[82:83]
  v_cndmask_b32 v253, v165, v164, s[84:85]
  s_mul_i32 s73, s57, 708
  s_sub_u32 s71, s58, 15
  s_lshl_b32 s71, s71, 2
  s_add_u32 s73, s73, s71
  s_add_u32 s73, s73, s56
  s_lshl_b32 s73, s73, 10
  s_mov_b32 s79, 4
  s_mov_b32 s78, 0
  s_setprio 2
  s_mov_b32 s77, 1
  s_branch L_QSP0
L_QSP:
  s_mov_b32 s70, 0
L_QSP_l:
  ds_read_b128 v[248:251], v246
  s_add_u32 s70, s70, 1
  s_waitcnt lgkmcnt(0)
  v_min_u32 v248, v248, v249
  v_min3_u32 v248, v248, v250, v251
  v_cmp_gt_u32 vcc, s77, v248
  s_cmp_lt_u32 s70, 0x400000
  s_cbranch_vccz L_QBK
  s_cbranch_scc1 L_QSP_l
  s_branch L_QBK
L_QSP0:
  s_mov_b32 s70, 0
L_QSP0_l:
  ds_read_b128 v[248:251], v246
  s_add_u32 s70, s70, 1
  s_waitcnt lgkmcnt(0)
  v_min_u32 v248, v248, v249
  v_min3_u32 v248, v248, v250, v251
  v_cmp_gt_u32 vcc, s77, v248
  s_cmp_lt_u32 s70, 0x400000
  s_cbranch_vccz L_QGO
  s_cbranch_scc1 L_QSP0_l
  s_branch L_QGO
L_QGO:
  ds_read_b128 v[152:155], v240 offset:0
  ds_read_b64_tr_b16 v[220:221], v244 offset:8192
  ds_read_b128 v[156:159], v240 offset:2048
  ds_read_b64_tr_b16 v[222:223], v244 offset:8704
  ds_read_b32 v247, v246
  ds_read_b128 v[160:163], v240 offset:4096
  ds_read_b64_tr_b16 v[224:225], v244 offset:16384
  ds_read_b128 v[164:167], v240 offset:6144
  ds_read_b64_tr_b16 v[226:227], v244 offset:16896
  ds_read_b128 v[168:171], v240 offset:8192
  ds_read_b64_tr_b16 v[216:217], v244 offset:0
  ds_read_b128 v[172:175], v240 offset:10240
  ds_read_b64_tr_b16 v[218:219], v244 offset:512
  ds_read_b128 v[176:179], v240 offset:12288
  ds_read_b128 v[192:195], v240 offset:20480
  ds_read_b128 v[180:183], v240 offset:14336
  ds_read_b128 v[196:199], v240 offset:22528
  ds_read_b128 v[184:187], v240 offset:16384
  ds_read_b128 v[200:203], v240 offset:24576
  ds_read_b128 v[188:191], v240 offset:18432
L_QLOOP:
  s_waitcnt lgkmcnt(11)
  v_mfma_f32_16x16x32_bf16 v[48:51], v[220:223], v[152:155], v[48:51]
  v_mfma_f32_16x16x32_bf16 v[100:103], v[152:155], v[224:227], v[100:103]
  s_waitcnt lgkmcnt(7)
  v_mfma_f32_16x16x32_bf16 v[52:55], v[220:223], v[156:159], v[52:55]
  v_mfma_f32_16x16x32_bf16 v[104:107], v[156:159], v[224:227], v[104:107]
  ds_read_b128 v[152:155], v241 offset:0
  v_mfma_f32_16x16x32_bf16 v[0:3], v[216:219], v[156:159], v[0:3]
  ds_read_b64_tr_b16 v[232:233], v244 offset:12288
  v_mfma_f32_16x16x32_bf16 v[56:59], v[220:223], v[160:163], v[56:59]
  v_mfma_f32_16x16x32_bf16 v[108:111], v[160:163], v[224:227], v[108:111]
  ds_read_b128 v[156:159], v241 offset:2048
  v_mfma_f32_16x16x32_bf16 v[4:7], v[216:219], v[160:163], v[4:7]
  ds_read_b64_tr_b16 v[234:235], v244 offset:12800
  v_mfma_f32_16x16x32_bf16 v[60:63], v[220:223], v[164:167], v[60:63]
  v_mfma_f32_16x16x32_bf16 v[112:115], v[164:167], v[224:227], v[112:115]
  ds_read_b128 v[160:163], v241 offset:4096
  v_mfma_f32_16x16x32_bf16 v[8:11], v[216:219], v[164:167], v[8:11]
  ds_read_b64_tr_b16 v[236:237], v244 offset:20480
  v_mfma_f32_16x16x32_bf16 v[64:67], v[220:223], v[168:171], v[64:67]
  s_add_u32 s77, s77, 1
  v_mfma_f32_16x16x32_bf16 v[116:119], v[168:171], v[224:227], v[116:119]
  ds_read_b128 v[164:167], v241 offset:6144
  v_mfma_f32_16x16x32_bf16 v[12:15], v[216:219], v[168:171], v[12:15]
  ds_read_b64_tr_b16 v[238:239], v244 offset:20992
  v_mfma_f32_16x16x32_bf16 v[68:71], v[220:223], v[172:175], v[68:71]
  s_add_u32 s78, s78, 1
  v_mfma_f32_16x16x32_bf16 v[120:123], v[172:175], v[224:227], v[120:123]
  ds_read_b128 v[168:171], v241 offset:8192
  v_mfma_f32_16x16x32_bf16 v[16:19], v[216:219], v[172:175], v[16:19]
  ds_read_b64_tr_b16 v[228:229], v244 offset:4096
  s_waitcnt lgkmcnt(15)
  v_mfma_f32_16x16x32_bf16 v[72:75], v[220:223], v[176:179], v[72:75]
  s_mov_b32 s76, 51200
  v_mfma_f32_16x16x32_bf16 v[124:127], v[176:179], v[224:227], v[124:127]
  ds_read_b128 v[172:175], v241 offset:10240
  v_mfma_f32_16x16x32_bf16 v[20:23], v[216:219], v[176:179], v[20:23]
  ds_read_b64_tr_b16 v[230:231], v244 offset:4608
  s_waitcnt lgkmcnt(15)
  v_mfma_f32_16x16x32_bf16 v[76:79], v[220:223], v[180:183], v[76:79]
  ds_read_b128 v[248:251], v246
  v_mfma_f32_16x16x32_bf16 v[128:131], v[180:183], v[224:227], v[128:131]
  ds_read_b128 v[176:179], v241 offset:12288
  v_mfma_f32_16x16x32_bf16 v[24:27], v[216:219], v[180:183], v[24:27]
  ds_read_b128 v[204:207], v241 offset:20480
  s_waitcnt lgkmcnt(15)
  v_mfma_f32_16x16x32_bf16 v[80:83], v[220:223], v[184:187], v[80:83]
  s_cmp_eq_u32 s78, 3
  s_cmov_b32 s76, -102400
  v_mfma_f32_16x16x32_bf16 v[132:135], v[184:187], v[224:227], v[132:135]
  ds_read_b128 v[180:183], v241 offset:14336
  v_mfma_f32_16x16x32_bf16 v[28:31], v[216:219], v[184:187], v[28:31]
  ds_read_b128 v[208:211], v241 offset:22528
  v_mfma_f32_16x16x32_bf16 v[84:87], v[220:223], v[188:191], v[84:87]
  s_cmov_b32 s78, 0
  v_add_u32 v240, s76, v240
  v_mfma_f32_16x16x32_bf16 v[136:139], v[188:191], v[224:227], v[136:139]
  ds_read_b128 v[184:187], v241 offset:16384
  v_mfma_f32_16x16x32_bf16 v[32:35], v[216:219], v[188:191], v[32:35]
  ds_read_b128 v[212:215], v241 offset:24576
  v_mfma_f32_16x16x32_bf16 v[88:91], v[220:223], v[192:195], v[88:91]
  v_add_u32 v244, s76, v244
  v_mfma_f32_16x16x32_bf16 v[140:143], v[192:195], v[224:227], v[140:143]
  ds_read_b128 v[188:191], v241 offset:18432
  v_mfma_f32_16x16x32_bf16 v[36:39], v[216:219], v[192:195], v[36:39]
  v_mfma_f32_16x16x32_bf16 v[92:95], v[220:223], v[196:199], v[92:95]
  s_waitcnt lgkmcnt(7)
  v_mfma_f32_16x16x32_bf16 v[144:147], v[196:199], v[224:227], v[144:147]
  v_min_u32 v248, v248, v249
  v_add_u32 v241, s76, v241
  v_mfma_f32_16x16x32_bf16 v[40:43], v[216:219], v[196:199], v[40:43]
  v_min3_u32 v248, v248, v250, v251
  v_mfma_f32_16x16x32_bf16 v[96:99], v[220:223], v[200:203], v[96:99]
  v_cmp_gt_u32 vcc, s77, v248
  v_mfma_f32_16x16x32_bf16 v[148:151], v[200:203], v[224:227], v[148:151]
  v_mfma_f32_16x16x32_bf16 v[44:47], v[216:219], v[200:203], v[44:47]
  v_mfma_f32_16x16x32_bf16 v[48:51], v[232:235], v[152:155], v[48:51]
  v_mfma_f32_16x16x32_bf16 v[100:103], v[152:155], v[236:239], v[100:103]
  s_cbranch_vccnz L_QSP
L_QBK:
  v_mfma_f32_16x16x32_bf16 v[52:55], v[232:235], v[156:159], v[52:55]
  v_add_u32_e64 v247, -1, s77
  v_mfma_f32_16x16x32_bf16 v[104:107], v[156:159], v[236:239], v[104:107]
  ds_read_b128 v[152:155], v240 offset:0
  v_mfma_f32_16x16x32_bf16 v[0:3], v[228:231], v[156:159], v[0:3]
  ds_read_b64_tr_b16 v[220:221], v244 offset:8192
  v_mfma_f32_16x16x32_bf16 v[56:59], v[232:235], v[160:163], v[56:59]
  v_mfma_f32_16x16x32_bf16 v[108:111], v[160:163], v[236:239], v[108:111]
  ds_read_b128 v[156:159], v240 offset:2048
  v_mfma_f32_16x16x32_bf16 v[4:7], v[228:231], v[160:163], v[4:7]
  ds_read_b64_tr_b16 v[222:223], v244 offset:8704
  v_mfma_f32_16x16x32_bf16 v[60:63], v[232:235], v[164:167], v[60:63]
  s_waitcnt lgkmcnt(4)
  ds_write_b32 v245, v247 offset:16
  v_mfma_f32_16x16x32_bf16 v[112:115], v[164:167], v[236:239], v[112:115]
  ds_read_b128 v[160:163], v240 offset:4096
  v_mfma_f32_16x16x32_bf16 v[8:11], v[228:231], v[164:167], v[8:11]
  ds_read_b64_tr_b16 v[224:225], v244 offset:16384
  v_mfma_f32_16x16x32_bf16 v[64:67], v[232:235], v[168:171], v[64:67]
  v_mfma_f32_16x16x32_bf16 v[116:119], v[168:171], v[236:239], v[116:119]
  ds_read_b128 v[164:167], v240 offset:6144
  v_mfma_f32_16x16x32_bf16 v[12:15], v[228:231], v[168:171], v[12:15]
  ds_read_b64_tr_b16 v[226:227], v244 offset:16896
  v_mfma_f32_16x16x32_bf16 v[68:71], v[232:235], v[172:175], v[68:71]
  v_mfma_f32_16x16x32_bf16 v[120:123], v[172:175], v[236:239], v[120:123]
  ds_read_b128 v[168:171], v240 offset:8192
  v_mfma_f32_16x16x32_bf16 v[16:19], v[228:231], v[172:175], v[16:19]
  ds_read_b64_tr_b16 v[216:217], v244 offset:0
  v_mfma_f32_16x16x32_bf16 v[72:75], v[232:235], v[176:179], v[72:75]
  v_mfma_f32_16x16x32_bf16 v[124:127], v[176:179], v[236:239], v[124:127]
  ds_read_b128 v[172:175], v240 offset:10240
  v_mfma_f32_16x16x32_bf16 v[20:23], v[228:231], v[176:179], v[20:23]
  ds_read_b64_tr_b16 v[218:219], v244 offset:512
  v_mfma_f32_16x16x32_bf16 v[76:79], v[232:235], v[180:183], v[76:79]
  v_mfma_f32_16x16x32_bf16 v[128:131], v[180:183], v[236:239], v[128:131]
  ds_read_b128 v[176:179], v240 offset:12288
  v_mfma_f32_16x16x32_bf16 v[24:27], v[228:231], v[180:183], v[24:27]
  ds_read_b128 v[192:195], v240 offset:20480
  v_mfma_f32_16x16x32_bf16 v[80:83], v[232:235], v[184:187], v[80:83]
  v_mfma_f32_16x16x32_bf16 v[132:135], v[184:187], v[236:239], v[132:135]
  ds_read_b128 v[180:183], v240 offset:14336
  v_mfma_f32_16x16x32_bf16 v[28:31], v[228:231], v[184:187], v[28:31]
  ds_read_b128 v[196:199], v240 offset:22528
  v_mfma_f32_16x16x32_bf16 v[84:87], v[232:235], v[188:191], v[84:87]
  v_mfma_f32_16x16x32_bf16 v[136:139], v[188:191], v[236:239], v[136:139]
  ds_read_b128 v[184:187], v240 offset:16384
  v_mfma_f32_16x16x32_bf16 v[32:35], v[228:231], v[188:191], v[32:35]
  ds_read_b128 v[200:203], v240 offset:24576
  v_mfma_f32_16x16x32_bf16 v[88:91], v[232:235], v[204:207], v[88:91]
  v_mfma_f32_16x16x32_bf16 v[140:143], v[204:207], v[236:239], v[140:143]
  ds_read_b128 v[188:191], v240 offset:18432
  v_mfma_f32_16x16x32_bf16 v[36:39], v[228:231], v[204:207], v[36:39]
  v_mfma_f32_16x16x32_bf16 v[92:95], v[232:235], v[208:211], v[92:95]
  v_mfma_f32_16x16x32_bf16 v[144:147], v[208:211], v[236:239], v[144:147]
  v_mfma_f32_16x16x32_bf16 v[40:43], v[228:231], v[208:211], v[40:43]
  v_mfma_f32_16x16x32_bf16 v[96:99], v[232:235], v[212:215], v[96:99]
  v_mfma_f32_16x16x32_bf16 v[148:151], v[212:215], v[236:239], v[148:151]
  v_mfma_f32_16x16x32_bf16 v[44:47], v[228:231], v[212:215], v[44:47]
  s_cmp_lt_u32 s77, 9
  s_cbranch_scc1 L_QLOOP
L_WQ_0:
  s_cbranch_execz L_WQ_1
  s_waitcnt lgkmcnt(0)
  v_and_b32 v250, 15, v254
  v_lshlrev_b32 v244, 4, v250
  v_add_u32 v244, 155648, v244
  v_and_b32 v245, 48, v254
  s_lshl_b32 s66, s56, 6
  s_add_u32 s66, s66, 161792
  v_add_u32 v246, s66, v245
  v_add_u32 v245, 159744, v245
  v_lshl_add_u32 v250, v250, 2, s66
  ds_read_b32 v232, v250 offset:512
  ds_read_b128 v[228:231], v246 offset:256
  ds_read_b128 v[234:237], v246
  ds_read_b128 v[212:215], v245 offset:0
  ds_read_b128 v[216:219], v245 offset:1024
  ds_read_b128 v[204:207], v244 offset:0
  v_mov_b32 v247, 159728
  ds_read_b64 v[248:249], v247
  v_mov_b32 v238, 0x3f803f80
  v_mov_b32 v239, 0x3f803f80
  v_mov_b32 v240, 0x3f803f80
  v_mov_b32 v241, 0x3f803f80
  v_lshlrev_b32 v250, 4, v254
  ds_read_b128 v[220:223], v245 offset:64
  ds_read_b128 v[224:227], v245 offset:1088
  ds_read_b128 v[208:211], v244 offset:256
  s_waitcnt lgkmcnt(3)
  v_pk_fma_f32 v[100:101], v[212:213], v[232:233], v[100:101] op_sel_hi:[1,0,1] neg_lo:[0,1,0] neg_hi:[0,1,0]
  v_pk_fma_f32 v[102:103], v[214:215], v[232:233], v[102:103] op_sel_hi:[1,0,1] neg_lo:[0,1,0] neg_hi:[0,1,0]
  v_pk_fma_f32 v[48:49], v[228:229], v[204:205], v[48:49] op_sel_hi:[1,0,1] neg_lo:[0,1,0] neg_hi:[0,1,0]
  v_pk_fma_f32 v[50:51], v[230:231], v[204:205], v[50:51] op_sel_hi:[1,0,1] neg_lo:[0,1,0] neg_hi:[0,1,0]
  v_pk_mul_f32 v[100:101], v[100:101], v[216:217]
  v_pk_mul_f32 v[102:103], v[102:103], v[218:219]
  v_pk_mul_f32 v[48:49], v[48:49], v[204:205] op_sel:[0,1] op_sel_hi:[1,1]
  v_pk_mul_f32 v[50:51], v[50:51], v[204:205] op_sel:[0,1] op_sel_hi:[1,1]
  v_cvt_pk_bf16_f32 v178, v100, v101
  v_cvt_pk_bf16_f32 v179, v102, v103
  v_cvt_pk_bf16_f32 v152, v48, v49
  v_cvt_pk_bf16_f32 v153, v50, v51
L_WQ_1:
  s_cbranch_execz L_WQ_2
  ds_read_b128 v[212:215], v245 offset:128
  ds_read_b128 v[216:219], v245 offset:1152
  ds_read_b128 v[204:207], v244 offset:512
  s_waitcnt lgkmcnt(3)
  v_pk_fma_f32 v[104:105], v[220:221], v[232:233], v[104:105] op_sel_hi:[1,0,1] neg_lo:[0,1,0] neg_hi:[0,1,0]
  v_pk_fma_f32 v[106:107], v[222:223], v[232:233], v[106:107] op_sel_hi:[1,0,1] neg_lo:[0,1,0] neg_hi:[0,1,0]
  v_pk_fma_f32 v[52:53], v[228:229], v[208:209], v[52:53] op_sel_hi:[1,0,1] neg_lo:[0,1,0] neg_hi:[0,1,0]
  v_pk_fma_f32 v[54:55], v[230:231], v[208:209], v[54:55] op_sel_hi:[1,0,1] neg_lo:[0,1,0] neg_hi:[0,1,0]
  v_pk_mul_f32 v[104:105], v[104:105], v[224:225]
  v_pk_mul_f32 v[106:107], v[106:107], v[226:227]
  v_pk_mul_f32 v[52:53], v[52:53], v[208:209] op_sel:[0,1] op_sel_hi:[1,1]
  v_pk_mul_f32 v[54:55], v[54:55], v[208:209] op_sel:[0,1] op_sel_hi:[1,1]
  v_pk_fma_f32 v[0:1], v[234:235], v[208:209], v[0:1] op_sel_hi:[1,0,1] neg_lo:[0,1,0] neg_hi:[0,1,0]
  v_pk_fma_f32 v[2:3], v[236:237], v[208:209], v[2:3] op_sel_hi:[1,0,1] neg_lo:[0,1,0] neg_hi:[0,1,0]
  v_cvt_pk_bf16_f32 v180, v104, v105
  v_cvt_pk_bf16_f32 v181, v106, v107
  v_cvt_pk_bf16_f32 v154, v52, v53
  v_cvt_pk_bf16_f32 v155, v54, v55
  v_cvt_pk_bf16_f32 v0, v0, v1
  v_cvt_pk_bf16_f32 v1, v2, v3
  v_mov_b32 v2, v211
  ds_read_b128 v[220:223], v245 offset:192
  ds_read_b128 v[224:227], v245 offset:1216
  ds_read_b128 v[208:211], v244 offset:768
  s_waitcnt lgkmcnt(3)
  v_pk_fma_f32 v[108:109], v[212:213], v[232:233], v[108:109] op_sel_hi:[1,0,1] neg_lo:[0,1,0] neg_hi:[0,1,0]
  v_pk_fma_f32 v[110:111], v[214:215], v[232:233], v[110:111] op_sel_hi:[1,0,1] neg_lo:[0,1,0] neg_hi:[0,1,0]
  v_pk_fma_f32 v[56:57], v[228:229], v[204:205], v[56:57] op_sel_hi:[1,0,1] neg_lo:[0,1,0] neg_hi:[0,1,0]
  v_pk_fma_f32 v[58:59], v[230:231], v[204:205], v[58:59] op_sel_hi:[1,0,1] neg_lo:[0,1,0] neg_hi:[0,1,0]
  v_pk_mul_f32 v[108:109], v[108:109], v[216:217]
  v_pk_mul_f32 v[110:111], v[110:111], v[218:219]
  v_pk_mul_f32 v[56:57], v[56:57], v[204:205] op_sel:[0,1] op_sel_hi:[1,1]
  v_pk_mul_f32 v[58:59], v[58:59], v[204:205] op_sel:[0,1] op_sel_hi:[1,1]
L_WQ_2:
  s_cbranch_execz L_WQ_3
  v_pk_fma_f32 v[4:5], v[234:235], v[204:205], v[4:5] op_sel_hi:[1,0,1] neg_lo:[0,1,0] neg_hi:[0,1,0]
  v_pk_fma_f32 v[6:7], v[236:237], v[204:205], v[6:7] op_sel_hi:[1,0,1] neg_lo:[0,1,0] neg_hi:[0,1,0]
  v_cvt_pk_bf16_f32 v182, v108, v109
  v_cvt_pk_bf16_f32 v183, v110, v111
  v_cvt_pk_bf16_f32 v156, v56, v57
  v_cvt_pk_bf16_f32 v157, v58, v59
  v_cvt_pk_bf16_f32 v4, v4, v5
  v_cvt_pk_bf16_f32 v5, v6, v7
  v_mov_b32 v6, v207
  ds_read_b128 v[212:215], v245 offset:256
  ds_read_b128 v[216:219], v245 offset:1280
  ds_read_b128 v[204:207], v244 offset:1024
  s_waitcnt lgkmcnt(3)
  v_pk_fma_f32 v[112:113], v[220:221], v[232:233], v[112:113] op_sel_hi:[1,0,1] neg_lo:[0,1,0] neg_hi:[0,1,0]
  v_pk_fma_f32 v[114:115], v[222:223], v[232:233], v[114:115] op_sel_hi:[1,0,1] neg_lo:[0,1,0] neg_hi:[0,1,0]
  v_pk_fma_f32 v[60:61], v[228:229], v[208:209], v[60:61] op_sel_hi:[1,0,1] neg_lo:[0,1,0] neg_hi:[0,1,0]
  v_pk_fma_f32 v[62:63], v[230:231], v[208:209], v[62:63] op_sel_hi:[1,0,1] neg_lo:[0,1,0] neg_hi:[0,1,0]
  v_pk_mul_f32 v[112:113], v[112:113], v[224:225]
  v_pk_mul_f32 v[114:115], v[114:115], v[226:227]
  v_pk_mul_f32 v[60:61], v[60:61], v[208:209] op_sel:[0,1] op_sel_hi:[1,1]
  v_pk_mul_f32 v[62:63], v[62:63], v[208:209] op_sel:[0,1] op_sel_hi:[1,1]
  v_pk_fma_f32 v[8:9], v[234:235], v[208:209], v[8:9] op_sel_hi:[1,0,1] neg_lo:[0,1,0] neg_hi:[0,1,0]
  v_pk_fma_f32 v[10:11], v[236:237], v[208:209], v[10:11] op_sel_hi:[1,0,1] neg_lo:[0,1,0] neg_hi:[0,1,0]
  v_cvt_pk_bf16_f32 v184, v112, v113
  v_cvt_pk_bf16_f32 v185, v114, v115
  v_cvt_pk_bf16_f32 v158, v60, v61
  v_cvt_pk_bf16_f32 v159, v62, v63
  v_cvt_pk_bf16_f32 v8, v8, v9
  v_cvt_pk_bf16_f32 v9, v10, v11
  v_mov_b32 v10, v211
  ds_read_b128 v[220:223], v245 offset:320
  ds_read_b128 v[224:227], v245 offset:1344
  ds_read_b128 v[208:211], v244 offset:1280
L_WQ_3:
  s_cbranch_execz L_WQ_4
  s_waitcnt lgkmcnt(3)
  v_pk_fma_f32 v[116:117], v[212:213], v[232:233], v[116:117] op_sel_hi:[1,0,1] neg_lo:[0,1,0] neg_hi:[0,1,0]
  v_pk_fma_f32 v[118:119], v[214:215], v[232:233], v[118:119] op_sel_hi:[1,0,1] neg_lo:[0,1,0] neg_hi:[0,1,0]
  v_pk_fma_f32 v[64:65], v[228:229], v[204:205], v[64:65] op_sel_hi:[1,0,1] neg_lo:[0,1,0] neg_hi:[0,1,0]
  v_pk_fma_f32 v[66:67], v[230:231], v[204:205], v[66:67] op_sel_hi:[1,0,1] neg_lo:[0,1,0] neg_hi:[0,1,0]
  v_pk_mul_f32 v[116:117], v[116:117], v[216:217]
  v_pk_mul_f32 v[118:119], v[118:119], v[218:219]
  v_pk_mul_f32 v[64:65], v[64:65], v[204:205] op_sel:[0,1] op_sel_hi:[1,1]
  v_pk_mul_f32 v[66:67], v[66:67], v[204:205] op_sel:[0,1] op_sel_hi:[1,1]
  v_pk_fma_f32 v[12:13], v[234:235], v[204:205], v[12:13] op_sel_hi:[1,0,1] neg_lo:[0,1,0] neg_hi:[0,1,0]
  v_pk_fma_f32 v[14:15], v[236:237], v[204:205], v[14:15] op_sel_hi:[1,0,1] neg_lo:[0,1,0] neg_hi:[0,1,0]
  v_cvt_pk_bf16_f32 v186, v116, v117
  v_cvt_pk_bf16_f32 v187, v118, v119
  v_cvt_pk_bf16_f32 v160, v64, v65
  v_cvt_pk_bf16_f32 v161, v66, v67
  v_cvt_pk_bf16_f32 v12, v12, v13
  v_cvt_pk_bf16_f32 v13, v14, v15
  v_mov_b32 v14, v207
  ds_read_b128 v[212:215], v245 offset:384
  ds_read_b128 v[216:219], v245 offset:1408
  ds_read_b128 v[204:207], v244 offset:1536
  s_waitcnt lgkmcnt(3)
  v_pk_fma_f32 v[120:121], v[220:221], v[232:233], v[120:121] op_sel_hi:[1,0,1] neg_lo:[0,1,0] neg_hi:[0,1,0]
  v_pk_fma_f32 v[122:123], v[222:223], v[232:233], v[122:123] op_sel_hi:[1,0,1] neg_lo:[0,1,0] neg_hi:[0,1,0]
  v_pk_fma_f32 v[68:69], v[228:229], v[208:209], v[68:69] op_sel_hi:[1,0,1] neg_lo:[0,1,0] neg_hi:[0,1,0]
  v_pk_fma_f32 v[70:71], v[230:231], v[208:209], v[70:71] op_sel_hi:[1,0,1] neg_lo:[0,1,0] neg_hi:[0,1,0]
  v_pk_mul_f32 v[120:121], v[120:121], v[224:225]
  v_pk_mul_f32 v[122:123], v[122:123], v[226:227]
  v_pk_mul_f32 v[68:69], v[68:69], v[208:209] op_sel:[0,1] op_sel_hi:[1,1]
  v_pk_mul_f32 v[70:71], v[70:71], v[208:209] op_sel:[0,1] op_sel_hi:[1,1]
  v_pk_fma_f32 v[16:17], v[234:235], v[208:209], v[16:17] op_sel_hi:[1,0,1] neg_lo:[0,1,0] neg_hi:[0,1,0]
  v_pk_fma_f32 v[18:19], v[236:237], v[208:209], v[18:19] op_sel_hi:[1,0,1] neg_lo:[0,1,0] neg_hi:[0,1,0]
  v_cvt_pk_bf16_f32 v188, v120, v121
L_WQ_4:
  s_cbranch_execz L_WQ_5
  v_cvt_pk_bf16_f32 v189, v122, v123
  v_cvt_pk_bf16_f32 v162, v68, v69
  v_cvt_pk_bf16_f32 v163, v70, v71
  v_cvt_pk_bf16_f32 v16, v16, v17
  v_cvt_pk_bf16_f32 v17, v18, v19
  v_mov_b32 v18, v211
  ds_read_b128 v[220:223], v245 offset:448
  ds_read_b128 v[224:227], v245 offset:1472
  ds_read_b128 v[208:211], v244 offset:1792
  s_waitcnt lgkmcnt(3)
  v_pk_fma_f32 v[124:125], v[212:213], v[232:233], v[124:125] op_sel_hi:[1,0,1] neg_lo:[0,1,0] neg_hi:[0,1,0]
  v_pk_fma_f32 v[126:127], v[214:215], v[232:233], v[126:127] op_sel_hi:[1,0,1] neg_lo:[0,1,0] neg_hi:[0,1,0]
  v_pk_fma_f32 v[72:73], v[228:229], v[204:205], v[72:73] op_sel_hi:[1,0,1] neg_lo:[0,1,0] neg_hi:[0,1,0]
  v_pk_fma_f32 v[74:75], v[230:231], v[204:205], v[74:75] op_sel_hi:[1,0,1] neg_lo:[0,1,0] neg_hi:[0,1,0]
  v_pk_mul_f32 v[124:125], v[124:125], v[216:217]
  v_pk_mul_f32 v[126:127], v[126:127], v[218:219]
  v_pk_mul_f32 v[72:73], v[72:73], v[204:205] op_sel:[0,1] op_sel_hi:[1,1]
  v_pk_mul_f32 v[74:75], v[74:75], v[204:205] op_sel:[0,1] op_sel_hi:[1,1]
  v_pk_fma_f32 v[20:21], v[234:235], v[204:205], v[20:21] op_sel_hi:[1,0,1] neg_lo:[0,1,0] neg_hi:[0,1,0]
  v_pk_fma_f32 v[22:23], v[236:237], v[204:205], v[22:23] op_sel_hi:[1,0,1] neg_lo:[0,1,0] neg_hi:[0,1,0]
  v_cvt_pk_bf16_f32 v190, v124, v125
  v_cvt_pk_bf16_f32 v191, v126, v127
  v_cvt_pk_bf16_f32 v164, v72, v73
  v_cvt_pk_bf16_f32 v165, v74, v75
  v_cvt_pk_bf16_f32 v20, v20, v21
  v_cvt_pk_bf16_f32 v21, v22, v23
  v_mov_b32 v22, v207
  ds_read_b128 v[212:215], v245 offset:512
  ds_read_b128 v[216:219], v245 offset:1536
  ds_read_b128 v[204:207], v244 offset:2048
  s_waitcnt lgkmcnt(3)
  v_pk_fma_f32 v[128:129], v[220:221], v[232:233], v[128:129] op_sel_hi:[1,0,1] neg_lo:[0,1,0] neg_hi:[0,1,0]
  v_pk_fma_f32 v[130:131], v[222:223], v[232:233], v[130:131] op_sel_hi:[1,0,1] neg_lo:[0,1,0] neg_hi:[0,1,0]
L_WQ_5:
  s_cbranch_execz L_WQ_6
  v_pk_fma_f32 v[76:77], v[228:229], v[208:209], v[76:77] op_sel_hi:[1,0,1] neg_lo:[0,1,0] neg_hi:[0,1,0]
  v_pk_fma_f32 v[78:79], v[230:231], v[208:209], v[78:79] op_sel_hi:[1,0,1] neg_lo:[0,1,0] neg_hi:[0,1,0]
  v_pk_mul_f32 v[128:129], v[128:129], v[224:225]
  v_pk_mul_f32 v[130:131], v[130:131], v[226:227]
  v_pk_mul_f32 v[76:77], v[76:77], v[208:209] op_sel:[0,1] op_sel_hi:[1,1]
  v_pk_mul_f32 v[78:79], v[78:79], v[208:209] op_sel:[0,1] op_sel_hi:[1,1]
  v_pk_fma_f32 v[24:25], v[234:235], v[208:209], v[24:25] op_sel_hi:[1,0,1] neg_lo:[0,1,0] neg_hi:[0,1,0]
  v_pk_fma_f32 v[26:27], v[236:237], v[208:209], v[26:27] op_sel_hi:[1,0,1] neg_lo:[0,1,0] neg_hi:[0,1,0]
  v_cvt_pk_bf16_f32 v192, v128, v129
  v_cvt_pk_bf16_f32 v193, v130, v131
  v_cvt_pk_bf16_f32 v166, v76, v77
  v_cvt_pk_bf16_f32 v167, v78, v79
  v_cvt_pk_bf16_f32 v24, v24, v25
  v_cvt_pk_bf16_f32 v25, v26, v27
  v_mov_b32 v26, v211
  ds_read_b128 v[220:223], v245 offset:576
  ds_read_b128 v[224:227], v245 offset:1600
  ds_read_b128 v[208:211], v244 offset:2304
  s_waitcnt lgkmcnt(3)
  v_pk_fma_f32 v[132:133], v[212:213], v[232:233], v[132:133] op_sel_hi:[1,0,1] neg_lo:[0,1,0] neg_hi:[0,1,0]
  v_pk_fma_f32 v[134:135], v[214:215], v[232:233], v[134:135] op_sel_hi:[1,0,1] neg_lo:[0,1,0] neg_hi:[0,1,0]
  v_pk_fma_f32 v[80:81], v[228:229], v[204:205], v[80:81] op_sel_hi:[1,0,1] neg_lo:[0,1,0] neg_hi:[0,1,0]
  v_pk_fma_f32 v[82:83], v[230:231], v[204:205], v[82:83] op_sel_hi:[1,0,1] neg_lo:[0,1,0] neg_hi:[0,1,0]
  v_pk_mul_f32 v[132:133], v[132:133], v[216:217]
  v_pk_mul_f32 v[134:135], v[134:135], v[218:219]
  v_pk_mul_f32 v[80:81], v[80:81], v[204:205] op_sel:[0,1] op_sel_hi:[1,1]
  v_pk_mul_f32 v[82:83], v[82:83], v[204:205] op_sel:[0,1] op_sel_hi:[1,1]
  v_pk_fma_f32 v[28:29], v[234:235], v[204:205], v[28:29] op_sel_hi:[1,0,1] neg_lo:[0,1,0] neg_hi:[0,1,0]
  v_pk_fma_f32 v[30:31], v[236:237], v[204:205], v[30:31] op_sel_hi:[1,0,1] neg_lo:[0,1,0] neg_hi:[0,1,0]
  v_cvt_pk_bf16_f32 v194, v132, v133
  v_cvt_pk_bf16_f32 v195, v134, v135
  v_cvt_pk_bf16_f32 v168, v80, v81
L_WQ_6:
  s_cbranch_execz L_WQ_7
  v_cvt_pk_bf16_f32 v169, v82, v83
  v_cvt_pk_bf16_f32 v28, v28, v29
  v_cvt_pk_bf16_f32 v29, v30, v31
  v_mov_b32 v30, v207
  ds_read_b128 v[212:215], v245 offset:640
  ds_read_b128 v[216:219], v245 offset:1664
  ds_read_b128 v[204:207], v244 offset:2560
  s_waitcnt lgkmcnt(3)
  v_pk_fma_f32 v[136:137], v[220:221], v[232:233], v[136:137] op_sel_hi:[1,0,1] neg_lo:[0,1,0] neg_hi:[0,1,0]
  v_pk_fma_f32 v[138:139], v[222:223], v[232:233], v[138:139] op_sel_hi:[1,0,1] neg_lo:[0,1,0] neg_hi:[0,1,0]
  v_pk_fma_f32 v[84:85], v[228:229], v[208:209], v[84:85] op_sel_hi:[1,0,1] neg_lo:[0,1,0] neg_hi:[0,1,0]
  v_pk_fma_f32 v[86:87], v[230:231], v[208:209], v[86:87] op_sel_hi:[1,0,1] neg_lo:[0,1,0] neg_hi:[0,1,0]
  v_pk_mul_f32 v[136:137], v[136:137], v[224:225]
  v_pk_mul_f32 v[138:139], v[138:139], v[226:227]
  v_pk_mul_f32 v[84:85], v[84:85], v[208:209] op_sel:[0,1] op_sel_hi:[1,1]
  v_pk_mul_f32 v[86:87], v[86:87], v[208:209] op_sel:[0,1] op_sel_hi:[1,1]
  v_pk_fma_f32 v[32:33], v[234:235], v[208:209], v[32:33] op_sel_hi:[1,0,1] neg_lo:[0,1,0] neg_hi:[0,1,0]
  v_pk_fma_f32 v[34:35], v[236:237], v[208:209], v[34:35] op_sel_hi:[1,0,1] neg_lo:[0,1,0] neg_hi:[0,1,0]
  v_cvt_pk_bf16_f32 v196, v136, v137
  v_cvt_pk_bf16_f32 v197, v138, v139
  v_cvt_pk_bf16_f32 v170, v84, v85
  v_cvt_pk_bf16_f32 v171, v86, v87
  v_cvt_pk_bf16_f32 v32, v32, v33
  v_cvt_pk_bf16_f32 v33, v34, v35
  v_mov_b32 v34, v211
  ds_read_b128 v[220:223], v245 offset:704
  ds_read_b128 v[224:227], v245 offset:1728
  ds_read_b128 v[208:211], v244 offset:2816
  s_waitcnt lgkmcnt(3)
  v_pk_fma_f32 v[140:141], v[212:213], v[232:233], v[140:141] op_sel_hi:[1,0,1] neg_lo:[0,1,0] neg_hi:[0,1,0]
  v_pk_fma_f32 v[142:143], v[214:215], v[232:233], v[142:143] op_sel_hi:[1,0,1] neg_lo:[0,1,0] neg_hi:[0,1,0]
  v_pk_fma_f32 v[88:89], v[228:229], v[204:205], v[88:89] op_sel_hi:[1,0,1] neg_lo:[0,1,0] neg_hi:[0,1,0]
  v_pk_fma_f32 v[90:91], v[230:231], v[204:205], v[90:91] op_sel_hi:[1,0,1] neg_lo:[0,1,0] neg_hi:[0,1,0]
L_WQ_7:
  s_cbranch_execz L_WQ_8
  v_pk_mul_f32 v[140:141], v[140:141], v[216:217]
  v_pk_mul_f32 v[142:143], v[142:143], v[218:219]
  v_pk_mul_f32 v[88:89], v[88:89], v[204:205] op_sel:[0,1] op_sel_hi:[1,1]
  v_pk_mul_f32 v[90:91], v[90:91], v[204:205] op_sel:[0,1] op_sel_hi:[1,1]
  v_pk_fma_f32 v[36:37], v[234:235], v[204:205], v[36:37] op_sel_hi:[1,0,1] neg_lo:[0,1,0] neg_hi:[0,1,0]
  v_pk_fma_f32 v[38:39], v[236:237], v[204:205], v[38:39] op_sel_hi:[1,0,1] neg_lo:[0,1,0] neg_hi:[0,1,0]
  v_cvt_pk_bf16_f32 v198, v140, v141
  v_cvt_pk_bf16_f32 v199, v142, v143
  v_cvt_pk_bf16_f32 v172, v88, v89
  v_cvt_pk_bf16_f32 v173, v90, v91
  v_cvt_pk_bf16_f32 v36, v36, v37
  v_cvt_pk_bf16_f32 v37, v38, v39
  v_mov_b32 v38, v207
  ds_read_b128 v[212:215], v245 offset:768
  ds_read_b128 v[216:219], v245 offset:1792
  ds_read_b128 v[204:207], v244 offset:3072
  s_waitcnt lgkmcnt(3)
  v_pk_fma_f32 v[144:145], v[220:221], v[232:233], v[144:145] op_sel_hi:[1,0,1] neg_lo:[0,1,0] neg_hi:[0,1,0]
  v_pk_fma_f32 v[146:147], v[222:223], v[232:233], v[146:147] op_sel_hi:[1,0,1] neg_lo:[0,1,0] neg_hi:[0,1,0]
  v_pk_fma_f32 v[92:93], v[228:229], v[208:209], v[92:93] op_sel_hi:[1,0,1] neg_lo:[0,1,0] neg_hi:[0,1,0]
  v_pk_fma_f32 v[94:95], v[230:231], v[208:209], v[94:95] op_sel_hi:[1,0,1] neg_lo:[0,1,0] neg_hi:[0,1,0]
  v_pk_mul_f32 v[144:145], v[144:145], v[224:225]
  v_pk_mul_f32 v[146:147], v[146:147], v[226:227]
  v_pk_mul_f32 v[92:93], v[92:93], v[208:209] op_sel:[0,1] op_sel_hi:[1,1]
  v_pk_mul_f32 v[94:95], v[94:95], v[208:209] op_sel:[0,1] op_sel_hi:[1,1]
  v_pk_fma_f32 v[40:41], v[234:235], v[208:209], v[40:41] op_sel_hi:[1,0,1] neg_lo:[0,1,0] neg_hi:[0,1,0]
  v_pk_fma_f32 v[42:43], v[236:237], v[208:209], v[42:43] op_sel_hi:[1,0,1] neg_lo:[0,1,0] neg_hi:[0,1,0]
  v_cvt_pk_bf16_f32 v200, v144, v145
  v_cvt_pk_bf16_f32 v201, v146, v147
  v_cvt_pk_bf16_f32 v174, v92, v93
  v_cvt_pk_bf16_f32 v175, v94, v95
  v_cvt_pk_bf16_f32 v40, v40, v41
L_WQ_8:
  s_cbranch_execz L_WQ_9
  v_cvt_pk_bf16_f32 v41, v42, v43
  v_mov_b32 v42, v211
  s_waitcnt lgkmcnt(0)
  v_pk_fma_f32 v[148:149], v[212:213], v[232:233], v[148:149] op_sel_hi:[1,0,1] neg_lo:[0,1,0] neg_hi:[0,1,0]
  v_pk_fma_f32 v[150:151], v[214:215], v[232:233], v[150:151] op_sel_hi:[1,0,1] neg_lo:[0,1,0] neg_hi:[0,1,0]
  v_pk_fma_f32 v[96:97], v[228:229], v[204:205], v[96:97] op_sel_hi:[1,0,1] neg_lo:[0,1,0] neg_hi:[0,1,0]
  v_pk_fma_f32 v[98:99], v[230:231], v[204:205], v[98:99] op_sel_hi:[1,0,1] neg_lo:[0,1,0] neg_hi:[0,1,0]
  v_pk_mul_f32 v[148:149], v[148:149], v[216:217]
  v_pk_mul_f32 v[150:151], v[150:151], v[218:219]
  v_pk_mul_f32 v[96:97], v[96:97], v[204:205] op_sel:[0,1] op_sel_hi:[1,1]
  v_pk_mul_f32 v[98:99], v[98:99], v[204:205] op_sel:[0,1] op_sel_hi:[1,1]
  v_pk_fma_f32 v[44:45], v[234:235], v[204:205], v[44:45] op_sel_hi:[1,0,1] neg_lo:[0,1,0] neg_hi:[0,1,0]
  v_pk_fma_f32 v[46:47], v[236:237], v[204:205], v[46:47] op_sel_hi:[1,0,1] neg_lo:[0,1,0] neg_hi:[0,1,0]
  v_cvt_pk_bf16_f32 v202, v148, v149
  v_cvt_pk_bf16_f32 v203, v150, v151
  v_cvt_pk_bf16_f32 v176, v96, v97
  v_cvt_pk_bf16_f32 v177, v98, v99
  v_cvt_pk_bf16_f32 v44, v44, v45
  v_cvt_pk_bf16_f32 v45, v46, v47
  v_mov_b32 v46, v207
  v_mfma_f32_16x16x16_bf16 v[48:51], v[154:155], v[0:1], 0
  v_mfma_f32_16x16x16_bf16 v[52:55], v[152:153], v[0:1], 0
  v_mfma_f32_16x16x16_bf16 v[56:59], v[156:157], v[4:5], 0
  v_mfma_f32_16x16x16_bf16 v[60:63], v[154:155], v[4:5], 0
  v_mfma_f32_16x16x16_bf16 v[64:67], v[158:159], v[8:9], 0
  v_mfma_f32_16x16x16_bf16 v[68:71], v[156:157], v[8:9], 0
  v_mfma_f32_16x16x16_bf16 v[72:75], v[160:161], v[12:13], 0
  v_mfma_f32_16x16x16_bf16 v[76:79], v[158:159], v[12:13], 0
  s_nop 0
  v_cndmask_b32 v48, v48, v49, s[80:81]
  v_cndmask_b32 v50, v50, v51, s[80:81]
  v_cndmask_b32 v52, v52, v53, s[80:81]
  v_cndmask_b32 v54, v54, v55, s[80:81]
  v_cndmask_b32 v56, v56, v57, s[80:81]
L_WQ_9:
  s_cbranch_execz L_WRET
  v_cndmask_b32 v58, v58, v59, s[80:81]
  v_cndmask_b32 v60, v60, v61, s[80:81]
  v_cndmask_b32 v62, v62, v63, s[80:81]
  v_cndmask_b32 v64, v64, v65, s[80:81]
  v_cndmask_b32 v66, v66, v67, s[80:81]
  v_cndmask_b32 v68, v68, v69, s[80:81]
  v_cndmask_b32 v70, v70, v71, s[80:81]
  v_cndmask_b32 v72, v72, v73, s[80:81]
  v_cndmask_b32 v74, v74, v75, s[80:81]
  v_cndmask_b32 v76, v76, v77, s[80:81]
  v_cndmask_b32 v78, v78, v79, s[80:81]
  v_cndmask_b32 v48, v52, v48, s[82:83]
  v_cndmask_b32 v49, v54, v50, s[84:85]
  v_cndmask_b32 v56, v60, v56, s[82:83]
  v_cndmask_b32 v57, v62, v58, s[84:85]
  v_cndmask_b32 v64, v68, v64, s[82:83]
  v_cndmask_b32 v65, v70, v66, s[84:85]
  v_cndmask_b32 v72, v76, v72, s[82:83]
  v_cndmask_b32 v73, v78, v74, s[84:85]
  v_mov_b32 v3, 0xf149f2ca
  v_cndmask_b32 v48, v3, v48, s[86:87]
  v_cndmask_b32 v49, v3, v49, s[88:89]
  v_max_f32 v3, v48, v49
  v_max_f32 v7, v56, v57
  v_max_f32 v11, v64, v65
  v_max_f32 v15, v72, v73
  v_permlane32_swap_b32 v3, v7
  s_nop 0
  v_permlane32_swap_b32 v11, v15
  v_max_f32 v3, v3, v7
  v_max_f32 v11, v11, v15
  s_nop 1
  v_permlane16_swap_b32 v3, v11
  v_max_f32 v7, v3, v11
  v_max_f32 v15, v3, v11
  s_nop 1
  v_permlane16_swap_b32 v7, v15
  v_mov_b32 v3, v7
  v_mov_b32 v11, v15
  s_nop 0
  v_permlane32_swap_b32 v3, v7
  v_permlane32_swap_b32 v11, v15
  v_mul_f32 v3, v3, v2
  v_mul_f32 v7, v7, v6
  v_mul_f32 v11, v11, v10
L_WQ_10:
  s_cbranch_execz L_WQ_11
  v_mul_f32 v15, v15, v14
  v_fma_f32 v48, v48, v2, -v3
  v_fma_f32 v49, v49, v2, -v3
  v_fma_f32 v56, v56, v6, -v7
  v_fma_f32 v57, v57, v6, -v7
  v_fma_f32 v64, v64, v10, -v11
  v_fma_f32 v65, v65, v10, -v11
  v_fma_f32 v72, v72, v14, -v15
  v_fma_f32 v73, v73, v14, -v15
  v_exp_f32 v48, v48
  v_exp_f32 v49, v49
  v_exp_f32 v56, v56
  v_exp_f32 v57, v57
  v_exp_f32 v64, v64
  v_exp_f32 v65, v65
  v_exp_f32 v72, v72
  v_exp_f32 v73, v73
  v_cvt_pk_bf16_f32 v3, v48, v49
  v_cvt_pk_bf16_f32 v7, v56, v57
  v_cvt_pk_bf16_f32 v11, v64, v65
  v_cvt_pk_bf16_f32 v15, v72, v73
  v_perm_b32 v52, v3, v3, v242
  v_perm_b32 v53, v3, v3, v243
  v_perm_b32 v54, v3, v3, v252
  v_perm_b32 v55, v3, v3, v253
  v_perm_b32 v60, v7, v7, v242
  v_perm_b32 v61, v7, v7, v243
  v_perm_b32 v62, v7, v7, v252
  v_perm_b32 v63, v7, v7, v253
  v_perm_b32 v68, v11, v11, v242
  v_perm_b32 v69, v11, v11, v243
  v_perm_b32 v70, v11, v11, v252
  v_perm_b32 v71, v11, v11, v253
  v_perm_b32 v76, v15, v15, v242
  v_perm_b32 v77, v15, v15, v243
  v_perm_b32 v78, v15, v15, v252
L_WQ_11:
  s_cbranch_execz L_WQ_12
  v_perm_b32 v79, v15, v15, v253
  v_mfma_f32_16x16x32_bf16 v[204:207], v[238:241], v[52:55], 0
  v_mfma_f32_16x16x32_bf16 v[48:51], v[178:181], v[52:55], 0
  v_mfma_f32_16x16x32_bf16 v[208:211], v[238:241], v[60:63], 0
  v_mfma_f32_16x16x32_bf16 v[56:59], v[180:183], v[60:63], 0
  v_mfma_f32_16x16x32_bf16 v[212:215], v[238:241], v[68:71], 0
  v_mfma_f32_16x16x32_bf16 v[64:67], v[182:185], v[68:71], 0
  v_mfma_f32_16x16x32_bf16 v[216:219], v[238:241], v[76:79], 0
  v_mfma_f32_16x16x32_bf16 v[72:75], v[184:187], v[76:79], 0
  s_nop 0
  v_rcp_f32 v2, v204
  s_nop 0
  v_rcp_f32 v6, v208
  s_nop 0
  v_rcp_f32 v10, v212
  s_nop 0
  v_rcp_f32 v14, v216
  v_pk_mul_f32 v[48:49], v[48:49], v[2:3] op_sel_hi:[1,0]
  v_pk_mul_f32 v[50:51], v[50:51], v[2:3] op_sel_hi:[1,0]
  v_pk_mul_f32 v[56:57], v[56:57], v[6:7] op_sel_hi:[1,0]
  v_pk_mul_f32 v[58:59], v[58:59], v[6:7] op_sel_hi:[1,0]
  v_pk_mul_f32 v[64:65], v[64:65], v[10:11] op_sel_hi:[1,0]
  v_pk_mul_f32 v[66:67], v[66:67], v[10:11] op_sel_hi:[1,0]
  v_pk_mul_f32 v[72:73], v[72:73], v[14:15] op_sel_hi:[1,0]
  v_pk_mul_f32 v[74:75], v[74:75], v[14:15] op_sel_hi:[1,0]
  v_cvt_pk_bf16_f32 v0, v48, v49
  v_cvt_pk_bf16_f32 v1, v50, v51
  v_cvt_pk_bf16_f32 v2, v56, v57
  v_cvt_pk_bf16_f32 v3, v58, v59
  v_cvt_pk_bf16_f32 v8, v64, v65
  v_cvt_pk_bf16_f32 v9, v66, v67
  v_cvt_pk_bf16_f32 v10, v72, v73
  v_cvt_pk_bf16_f32 v11, v74, v75
  v_permlane16_swap_b32 v0, v2
  v_permlane16_swap_b32 v1, v3
  v_permlane16_swap_b32 v8, v10
  v_permlane16_swap_b32 v9, v11
  buffer_store_dwordx4 v[0:3], v250, s[40:43], s73 offen sc1
  s_add_u32 s73, s73, 120832
  buffer_store_dwordx4 v[8:11], v250, s[40:43], s73 offen sc1
L_WQ_12:
  s_cbranch_execz L_WQ_13
  s_add_u32 s73, s73, 120832
  v_mfma_f32_16x16x16_bf16 v[80:83], v[162:163], v[16:17], 0
  v_mfma_f32_16x16x16_bf16 v[84:87], v[160:161], v[16:17], 0
  v_mfma_f32_16x16x16_bf16 v[88:91], v[164:165], v[20:21], 0
  v_mfma_f32_16x16x16_bf16 v[92:95], v[162:163], v[20:21], 0
  v_mfma_f32_16x16x16_bf16 v[96:99], v[166:167], v[24:25], 0
  v_mfma_f32_16x16x16_bf16 v[100:103], v[164:165], v[24:25], 0
  v_mfma_f32_16x16x16_bf16 v[104:107], v[168:169], v[28:29], 0
  v_mfma_f32_16x16x16_bf16 v[108:111], v[166:167], v[28:29], 0
  s_nop 0
  v_cndmask_b32 v80, v80, v81, s[80:81]
  v_cndmask_b32 v82, v82, v83, s[80:81]
  v_cndmask_b32 v84, v84, v85, s[80:81]
  v_cndmask_b32 v86, v86, v87, s[80:81]
  v_cndmask_b32 v88, v88, v89, s[80:81]
  v_cndmask_b32 v90, v90, v91, s[80:81]
  v_cndmask_b32 v92, v92, v93, s[80:81]
  v_cndmask_b32 v94, v94, v95, s[80:81]
  v_cndmask_b32 v96, v96, v97, s[80:81]
  v_cndmask_b32 v98, v98, v99, s[80:81]
  v_cndmask_b32 v100, v100, v101, s[80:81]
  v_cndmask_b32 v102, v102, v103, s[80:81]
  v_cndmask_b32 v104, v104, v105, s[80:81]
  v_cndmask_b32 v106, v106, v107, s[80:81]
  v_cndmask_b32 v108, v108, v109, s[80:81]
  v_cndmask_b32 v110, v110, v111, s[80:81]
  v_cndmask_b32 v80, v84, v80, s[82:83]
  v_cndmask_b32 v81, v86, v82, s[84:85]
  v_cndmask_b32 v88, v92, v88, s[82:83]
  v_cndmask_b32 v89, v94, v90, s[84:85]
  v_cndmask_b32 v96, v100, v96, s[82:83]
  v_cndmask_b32 v97, v102, v98, s[84:85]
  v_cndmask_b32 v104, v108, v104, s[82:83]
L_WQ_13:
  s_cbranch_execz L_WQ_14
  v_cndmask_b32 v105, v110, v106, s[84:85]
  v_max_f32 v19, v80, v81
  v_max_f32 v23, v88, v89
  v_max_f32 v27, v96, v97
  v_max_f32 v31, v104, v105
  v_permlane32_swap_b32 v19, v23
  s_nop 0
  v_permlane32_swap_b32 v27, v31
  v_max_f32 v19, v19, v23
  v_max_f32 v27, v27, v31
  s_nop 1
  v_permlane16_swap_b32 v19, v27
  v_max_f32 v23, v19, v27
  v_max_f32 v31, v19, v27
  s_nop 1
  v_permlane16_swap_b32 v23, v31
  v_mov_b32 v19, v23
  v_mov_b32 v27, v31
  s_nop 0
  v_permlane32_swap_b32 v19, v23
  v_permlane32_swap_b32 v27, v31
  v_mul_f32 v19, v19, v18
  v_mul_f32 v23, v23, v22
  v_mul_f32 v27, v27, v26
  v_mul_f32 v31, v31, v30
  v_fma_f32 v80, v80, v18, -v19
  v_fma_f32 v81, v81, v18, -v19
  v_fma_f32 v88, v88, v22, -v23
  v_fma_f32 v89, v89, v22, -v23
  v_fma_f32 v96, v96, v26, -v27
  v_fma_f32 v97, v97, v26, -v27
  v_fma_f32 v104, v104, v30, -v31
  v_fma_f32 v105, v105, v30, -v31
  v_exp_f32 v80, v80
  v_exp_f32 v81, v81
  v_exp_f32 v88, v88
  v_exp_f32 v89, v89
  v_exp_f32 v96, v96
  v_exp_f32 v97, v97
  v_exp_f32 v104, v104
  v_exp_f32 v105, v105
  v_cvt_pk_bf16_f32 v19, v80, v81
  v_cvt_pk_bf16_f32 v23, v88, v89
  v_cvt_pk_bf16_f32 v27, v96, v97
  v_cvt_pk_bf16_f32 v31, v104, v105
  v_perm_b32 v84, v19, v19, v242
  v_perm_b32 v85, v19, v19, v243
  v_perm_b32 v86, v19, v19, v252
  v_perm_b32 v87, v19, v19, v253
L_WQ_14:
  s_cbranch_execz L_WQ_15
  v_perm_b32 v92, v23, v23, v242
  v_perm_b32 v93, v23, v23, v243
  v_perm_b32 v94, v23, v23, v252
  v_perm_b32 v95, v23, v23, v253
  v_perm_b32 v100, v27, v27, v242
  v_perm_b32 v101, v27, v27, v243
  v_perm_b32 v102, v27, v27, v252
  v_perm_b32 v103, v27, v27, v253
  v_perm_b32 v108, v31, v31, v242
  v_perm_b32 v109, v31, v31, v243
  v_perm_b32 v110, v31, v31, v252
  v_perm_b32 v111, v31, v31, v253
  v_mfma_f32_16x16x32_bf16 v[220:223], v[238:241], v[84:87], 0
  v_mfma_f32_16x16x32_bf16 v[80:83], v[186:189], v[84:87], 0
  v_mfma_f32_16x16x32_bf16 v[224:227], v[238:241], v[92:95], 0
  v_mfma_f32_16x16x32_bf16 v[88:91], v[188:191], v[92:95], 0
  v_mfma_f32_16x16x32_bf16 v[204:207], v[238:241], v[100:103], 0
  v_mfma_f32_16x16x32_bf16 v[96:99], v[190:193], v[100:103], 0
  v_mfma_f32_16x16x32_bf16 v[208:211], v[238:241], v[108:111], 0
  v_mfma_f32_16x16x32_bf16 v[104:107], v[192:195], v[108:111], 0
  s_nop 0
  v_rcp_f32 v18, v220
  s_nop 0
  v_rcp_f32 v22, v224
  s_nop 0
  v_rcp_f32 v26, v204
  s_nop 0
  v_rcp_f32 v30, v208
  v_pk_mul_f32 v[80:81], v[80:81], v[18:19] op_sel_hi:[1,0]
  v_pk_mul_f32 v[82:83], v[82:83], v[18:19] op_sel_hi:[1,0]
  v_pk_mul_f32 v[88:89], v[88:89], v[22:23] op_sel_hi:[1,0]
  v_pk_mul_f32 v[90:91], v[90:91], v[22:23] op_sel_hi:[1,0]
  v_pk_mul_f32 v[96:97], v[96:97], v[26:27] op_sel_hi:[1,0]
  v_pk_mul_f32 v[98:99], v[98:99], v[26:27] op_sel_hi:[1,0]
  v_pk_mul_f32 v[104:105], v[104:105], v[30:31] op_sel_hi:[1,0]
  v_pk_mul_f32 v[106:107], v[106:107], v[30:31] op_sel_hi:[1,0]
  v_cvt_pk_bf16_f32 v16, v80, v81
L_WQ_15:
  s_cbranch_execz L_WQ_16
  v_cvt_pk_bf16_f32 v17, v82, v83
  v_cvt_pk_bf16_f32 v18, v88, v89
  v_cvt_pk_bf16_f32 v19, v90, v91
  v_cvt_pk_bf16_f32 v24, v96, v97
  v_cvt_pk_bf16_f32 v25, v98, v99
  v_cvt_pk_bf16_f32 v26, v104, v105
  v_cvt_pk_bf16_f32 v27, v106, v107
  v_permlane16_swap_b32 v16, v18
  v_permlane16_swap_b32 v17, v19
  v_permlane16_swap_b32 v24, v26
  v_permlane16_swap_b32 v25, v27
  buffer_store_dwordx4 v[16:19], v250, s[40:43], s73 offen sc1
  s_add_u32 s73, s73, 120832
  buffer_store_dwordx4 v[24:27], v250, s[40:43], s73 offen sc1
  s_add_u32 s73, s73, 120832
  v_mfma_f32_16x16x16_bf16 v[112:115], v[170:171], v[32:33], 0
  v_mfma_f32_16x16x16_bf16 v[116:119], v[168:169], v[32:33], 0
  v_mfma_f32_16x16x16_bf16 v[120:123], v[172:173], v[36:37], 0
  v_mfma_f32_16x16x16_bf16 v[124:127], v[170:171], v[36:37], 0
  v_mfma_f32_16x16x16_bf16 v[128:131], v[174:175], v[40:41], 0
  v_mfma_f32_16x16x16_bf16 v[132:135], v[172:173], v[40:41], 0
  v_mfma_f32_16x16x16_bf16 v[136:139], v[176:177], v[44:45], 0
  v_mfma_f32_16x16x16_bf16 v[140:143], v[174:175], v[44:45], 0
  s_nop 0
  v_cndmask_b32 v112, v112, v113, s[80:81]
  v_cndmask_b32 v114, v114, v115, s[80:81]
  v_cndmask_b32 v116, v116, v117, s[80:81]
  v_cndmask_b32 v118, v118, v119, s[80:81]
  v_cndmask_b32 v120, v120, v121, s[80:81]
  v_cndmask_b32 v122, v122, v123, s[80:81]
  v_cndmask_b32 v124, v124, v125, s[80:81]
  v_cndmask_b32 v126, v126, v127, s[80:81]
  v_cndmask_b32 v128, v128, v129, s[80:81]
  v_cndmask_b32 v130, v130, v131, s[80:81]
  v_cndmask_b32 v132, v132, v133, s[80:81]
L_WQ_16:
  s_cbranch_execz L_WQ_17
  v_cndmask_b32 v134, v134, v135, s[80:81]
  v_cndmask_b32 v136, v136, v137, s[80:81]
  v_cndmask_b32 v138, v138, v139, s[80:81]
  v_cndmask_b32 v140, v140, v141, s[80:81]
  v_cndmask_b32 v142, v142, v143, s[80:81]
  v_cndmask_b32 v112, v116, v112, s[82:83]
  v_cndmask_b32 v113, v118, v114, s[84:85]
  v_cndmask_b32 v120, v124, v120, s[82:83]
  v_cndmask_b32 v121, v126, v122, s[84:85]
  v_cndmask_b32 v128, v132, v128, s[82:83]
  v_cndmask_b32 v129, v134, v130, s[84:85]
  v_cndmask_b32 v136, v140, v136, s[82:83]
  v_cndmask_b32 v137, v142, v138, s[84:85]
  v_max_f32 v35, v112, v113
  v_max_f32 v39, v120, v121
  v_max_f32 v43, v128, v129
  v_max_f32 v47, v136, v137
  v_permlane32_swap_b32 v35, v39
  s_nop 0
  v_permlane32_swap_b32 v43, v47
  v_max_f32 v35, v35, v39
  v_max_f32 v43, v43, v47
  s_nop 1
  v_permlane16_swap_b32 v35, v43
  v_max_f32 v39, v35, v43
  v_max_f32 v47, v35, v43
  s_nop 1
  v_permlane16_swap_b32 v39, v47
  v_mov_b32 v35, v39
  v_mov_b32 v43, v47
  s_nop 0
  v_permlane32_swap_b32 v35, v39
  v_permlane32_swap_b32 v43, v47
  v_mul_f32 v35, v35, v34
  v_mul_f32 v39, v39, v38
  v_mul_f32 v43, v43, v42
  v_mul_f32 v47, v47, v46
  v_fma_f32 v112, v112, v34, -v35
  v_fma_f32 v113, v113, v34, -v35
  v_fma_f32 v120, v120, v38, -v39
  v_fma_f32 v121, v121, v38, -v39
  v_fma_f32 v128, v128, v42, -v43
  v_fma_f32 v129, v129, v42, -v43
  v_fma_f32 v136, v136, v46, -v47
  v_fma_f32 v137, v137, v46, -v47
L_WQ_17:
  s_cbranch_execz L_WQ_18
  v_exp_f32 v112, v112
  v_exp_f32 v113, v113
  v_exp_f32 v120, v120
  v_exp_f32 v121, v121
  v_exp_f32 v128, v128
  v_exp_f32 v129, v129
  v_exp_f32 v136, v136
  v_exp_f32 v137, v137
  v_cvt_pk_bf16_f32 v35, v112, v113
  v_cvt_pk_bf16_f32 v39, v120, v121
  v_cvt_pk_bf16_f32 v43, v128, v129
  v_cvt_pk_bf16_f32 v47, v136, v137
  v_perm_b32 v116, v35, v35, v242
  v_perm_b32 v117, v35, v35, v243
  v_perm_b32 v118, v35, v35, v252
  v_perm_b32 v119, v35, v35, v253
  v_perm_b32 v124, v39, v39, v242
  v_perm_b32 v125, v39, v39, v243
  v_perm_b32 v126, v39, v39, v252
  v_perm_b32 v127, v39, v39, v253
  v_perm_b32 v132, v43, v43, v242
  v_perm_b32 v133, v43, v43, v243
  v_perm_b32 v134, v43, v43, v252
  v_perm_b32 v135, v43, v43, v253
  v_perm_b32 v140, v47, v47, v242
  v_perm_b32 v141, v47, v47, v243
  v_perm_b32 v142, v47, v47, v252
  v_perm_b32 v143, v47, v47, v253
  v_mfma_f32_16x16x32_bf16 v[212:215], v[238:241], v[116:119], 0
  v_mfma_f32_16x16x32_bf16 v[112:115], v[194:197], v[116:119], 0
  v_mfma_f32_16x16x32_bf16 v[216:219], v[238:241], v[124:127], 0
  v_mfma_f32_16x16x32_bf16 v[120:123], v[196:199], v[124:127], 0
  v_mfma_f32_16x16x32_bf16 v[220:223], v[238:241], v[132:135], 0
  v_mfma_f32_16x16x32_bf16 v[128:131], v[198:201], v[132:135], 0
  v_mfma_f32_16x16x32_bf16 v[224:227], v[238:241], v[140:143], 0
L_WQ_18:
  s_cbranch_execz L_WQ_19
  v_mfma_f32_16x16x32_bf16 v[136:139], v[200:203], v[140:143], 0
  v_rcp_f32 v34, v212
  s_nop 0
  v_rcp_f32 v38, v216
  s_nop 0
  v_rcp_f32 v42, v220
  s_nop 0
  v_rcp_f32 v46, v224
  v_pk_mul_f32 v[112:113], v[112:113], v[34:35] op_sel_hi:[1,0]
  v_pk_mul_f32 v[114:115], v[114:115], v[34:35] op_sel_hi:[1,0]
  v_pk_mul_f32 v[120:121], v[120:121], v[38:39] op_sel_hi:[1,0]
  v_pk_mul_f32 v[122:123], v[122:123], v[38:39] op_sel_hi:[1,0]
  v_pk_mul_f32 v[128:129], v[128:129], v[42:43] op_sel_hi:[1,0]
  v_pk_mul_f32 v[130:131], v[130:131], v[42:43] op_sel_hi:[1,0]
  v_pk_mul_f32 v[136:137], v[136:137], v[46:47] op_sel_hi:[1,0]
  v_pk_mul_f32 v[138:139], v[138:139], v[46:47] op_sel_hi:[1,0]
  v_cvt_pk_bf16_f32 v32, v112, v113
  v_cvt_pk_bf16_f32 v33, v114, v115
  v_cvt_pk_bf16_f32 v34, v120, v121
  v_cvt_pk_bf16_f32 v35, v122, v123
  v_cvt_pk_bf16_f32 v40, v128, v129
  v_cvt_pk_bf16_f32 v41, v130, v131
  v_cvt_pk_bf16_f32 v42, v136, v137
  v_cvt_pk_bf16_f32 v43, v138, v139
  v_permlane16_swap_b32 v32, v34
  v_permlane16_swap_b32 v33, v35
  v_permlane16_swap_b32 v40, v42
  v_permlane16_swap_b32 v41, v43
  buffer_store_dwordx4 v[32:35], v250, s[40:43], s73 offen sc1
  s_add_u32 s73, s73, 120832
  buffer_store_dwordx4 v[40:43], v250, s[40:43], s73 offen sc1
  s_add_u32 s73, s73, 120832
  s_mov_b64 exec, 1
  s_waitcnt vmcnt(0)
  buffer_store_dwordx2 v[248:249], v254, s[36:39], s74 offen sc1
  s_mov_b64 exec, -1
  v_readfirstlane_b32 s64, v248
  v_readfirstlane_b32 s65, v249
  s_lshl_b32 s66, s56, 2
  s_add_u32 s66, s66, 159712
  v_mov_b32 v250, s66
  v_mov_b32 v251, 9
  ds_write_b32 v250, v251
L_WQ_19:
  s_cbranch_execz L_WRET
  s_setprio 0
  v_lshlrev_b32 v246, 4, v254
  v_add_u32 v240, s95, v246
  v_add_u32 v241, 0x10000, v240
  v_add_u32 v242, 0x20000, v240
  s_lshl_b32 s66, s60, 2
  s_add_u32 s66, s66, 159696
  v_mov_b32 v238, s66
  s_mov_b32 s70, 0
L_pw_84:
  ds_read_b32 v239, v238
  s_add_u32 s70, s70, 1
  s_waitcnt lgkmcnt(0)
  v_cmp_gt_u32 vcc, 10, v239
  s_cmp_lt_u32 s70, 0x400000
  s_cbranch_vccz L_pwd_85
  s_cbranch_scc1 L_pw_84
L_pwd_85:
  s_add_u32 s68, s91, 6
  s_cmp_ge_u32 s68, s92
  s_cselect_b32 s66, s92, 0
  s_sub_u32 s68, s68, s66
  s_add_u32 s66, s93, s68
  s_lshl_b32 s66, s66, 11
  buffer_load_dwordx4 v[192:195], v246, s[36:39], s66 offen sc1
  buffer_load_dwordx4 v[196:199], v246, s[36:39], s66 offen offset:1024 sc1
  s_add_u32 s68, s91, 7
  s_cmp_ge_u32 s68, s92
  s_cselect_b32 s66, s92, 0
  s_sub_u32 s68, s68, s66
  s_add_u32 s66, s93, s68
  s_lshl_b32 s66, s66, 11
  buffer_load_dwordx4 v[200:203], v246, s[36:39], s66 offen sc1
  buffer_load_dwordx4 v[204:207], v246, s[36:39], s66 offen offset:1024 sc1
  s_add_u32 s68, s91, 8
  s_cmp_ge_u32 s68, s92
  s_cselect_b32 s66, s92, 0
  s_sub_u32 s68, s68, s66
  s_add_u32 s66, s93, s68
  s_lshl_b32 s66, s66, 11
  buffer_load_dwordx4 v[208:211], v246, s[36:39], s66 offen sc1
  buffer_load_dwordx4 v[212:215], v246, s[36:39], s66 offen offset:1024 sc1
  s_add_u32 s68, s91, 9
  s_cmp_ge_u32 s68, s92
  s_cselect_b32 s66, s92, 0
  s_sub_u32 s68, s68, s66
  s_add_u32 s66, s93, s68
  s_lshl_b32 s66, s66, 11
  buffer_load_dwordx4 v[216:219], v246, s[36:39], s66 offen sc1
  buffer_load_dwordx4 v[220:223], v246, s[36:39], s66 offen offset:1024 sc1
  s_branch L_P2
L_CODE_END:
  s_endpgm
.section .rodata,"a"
.p2align 6
.amdhsa_kernel recurrent_scan__sliding_local_dilated__swiglu_ffn__prompt_kernel
  .amdhsa_next_free_vgpr 256
  .amdhsa_next_free_sgpr 102
  .amdhsa_accum_offset 256
  .amdhsa_group_segment_fixed_size 0
  .amdhsa_kernarg_size 80
  .amdhsa_user_sgpr_count 2
  .amdhsa_user_sgpr_kernarg_segment_ptr 1
  .amdhsa_system_sgpr_workgroup_id_x 1
.end_amdhsa_kernel
```
